```python
import torch

def _softmax(x, axis=-1):
    return torch.softmax(x, dim=axis)
def _gelu(x):
    return torch.nn.functional.gelu(x, approximate="tanh")
def _silu(x):
    return torch.nn.functional.silu(x)
def _sigmoid(x):
    return torch.sigmoid(x)
def _layernorm(x, axis=-1, eps=1e-5):
    m = x.mean(dim=axis, keepdim=True)
    v = x.var(dim=axis, keepdim=True, unbiased=False)
    return (x - m) / torch.sqrt(v + eps)
def _scatter_add(tgt, idx, src, axis=0):
    return tgt.clone().index_add_(axis, idx, src)
def _segment_sum(src, seg, n):
    out = torch.zeros((n,) + src.shape[1:], dtype=src.dtype)
    return out.index_add_(0, seg, src)
def _pad(x, pw):
    flat = tuple(v for pair in reversed(pw) for v in pair)
    return torch.nn.functional.pad(x, flat)

kernel_name = 'sequential_preLN__grouped_kv_mqa__mixer_channel_mlp__prompt'

def setup_inputs():

    _w = (lambda a: (lambda t: t.to(torch.bfloat16) if t.is_floating_point() else t)(torch.as_tensor(a)))
    def _A_setup():
        B, S, D, H = 1, 2048, 640, 32
        Dh = D // H
        return {
            "x": _w((lambda *s: torch.randn(*s, dtype=torch.bfloat16) * 0.05)(B, S, D)),
            "wq": _w((lambda *s: torch.randn(*s, dtype=torch.bfloat16) * 0.05)(D, H * Dh)),
            "wk": _w((lambda *s: torch.randn(*s, dtype=torch.bfloat16) * 0.05)(D, Dh)),
            "wv": _w((lambda *s: torch.randn(*s, dtype=torch.bfloat16) * 0.05)(D, Dh)),
            "wo": _w((lambda *s: torch.randn(*s, dtype=torch.bfloat16) * 0.05)(H * Dh, D)),
        }
    _A_in = _A_setup()

    def _B_setup():
        B, S, D, F = 1, 2048, 640, 1728
        return {
            "x": _w((lambda *s: torch.randn(*s, dtype=torch.bfloat16) * 0.05)(B, S, D)),
            "w1": _w((lambda *s: torch.randn(*s, dtype=torch.bfloat16) * 3.2)(D, F) * (D ** -0.5)),
            "b1": _w((lambda *s: torch.randn(*s, dtype=torch.bfloat16) * 1.6)(F)),
            "w2": _w((lambda *s: torch.randn(*s, dtype=torch.bfloat16) * 0.2)(F, D) * (F ** -0.5)),
            "b2": _w((lambda *s: torch.randn(*s, dtype=torch.bfloat16) * 0.4)(D)),
        }
    _B_in = _B_setup()

    return {
        "A_x": _A_in["x"],
        "A_wq": _A_in["wq"],
        "A_wk": _A_in["wk"],
        "A_wv": _A_in["wv"],
        "A_wo": _A_in["wo"],
        "B_x": _B_in["x"],
        "B_w1": _B_in["w1"],
        "B_b1": _B_in["b1"],
        "B_w2": _B_in["w2"],
        "B_b2": _B_in["b2"],
    }

def reference(A_x, A_wq, A_wk, A_wv, A_wo, B_x, B_w1, B_b1, B_w2, B_b2):
    def _A_ref(x, wq, wk, wv, wo):
        B, S, D = x.shape
        H = 32
        Dh = D // H
        q = (lambda x, *d: x.permute(*d))((x @ wq).reshape(B, S, H, Dh), 0, 2, 1, 3)
        k = x @ wk
        v = x @ wv
        scores = torch.einsum("bhqd,bkd->bhqk", q, k) * (Dh ** -0.5)
        p = _softmax(scores, axis=-1)
        o = torch.einsum("bhqk,bkd->bhqd", p, v)
        return (lambda x, *d: x.permute(*d))(o, 0, 2, 1, 3).reshape(B, S, H * Dh) @ wo

    def _B_ref(x, w1, b1, w2, b2):
        y = _layernorm(x, axis=-1)
        h = _gelu(torch.einsum("bsd,df->bsf", y, w1) + b1)
        return torch.einsum("bsf,fd->bsd", h, w2) + b2

    x = A_x
    h = x + _A_ref(_layernorm(x, axis=-1), A_wq, A_wk, A_wv, A_wo)
    h2 = h + _B_ref(_layernorm(h, axis=-1), B_w1, B_b1, B_w2, B_b2)
    return h2
```

```asm
; @launch grid=(256,1,1) block=(512,1,1) lds=163840
.amdgcn_target "amdgcn-amd-amdhsa--gfx950"
.text
.globl sequential_preLN__grouped_kv_mqa__mixer_channel_mlp__prompt_kernel
.p2align 8
.type sequential_preLN__grouped_kv_mqa__mixer_channel_mlp__prompt_kernel,@function
sequential_preLN__grouped_kv_mqa__mixer_channel_mlp__prompt_kernel:
    s_cmp_ge_u32 s2, 256
    s_cbranch_scc1 L_mega_end
    s_load_dwordx8 s[28:35], s[0:1], 0
    s_load_dwordx2 s[46:47], s[0:1], 96
    s_load_dwordx8 s[36:43], s[0:1], 48
    s_load_dwordx2 s[44:45], s[0:1], 80
    s_load_dwordx2 s[48:49], s[0:1], 32
    s_getpc_b64 s[60:61]
    s_lshr_b32 s50, s2, 3
    s_lshl_b32 s50, s50, 11
    v_lshl_add_u32 v12, v0, 7, s50
    v_min_u32 v12, L_mega_last-sequential_preLN__grouped_kv_mqa__mixer_channel_mlp__prompt_kernel-256, v12
    v_cmp_gt_u32 vcc, 16, v0
    s_and_saveexec_b64 s[52:53], vcc
    s_cbranch_execz L_sequ_cpf_1
    global_load_dword v13, v12, s[60:61]
L_sequ_cpf_1:
    s_mov_b64 exec, -1
    v_lshrrev_b32 v5, 6, v0
    v_and_b32 v1, 63, v0
    v_readfirstlane_b32 s20, v5
    s_and_b32 s50, s2, 7
    s_lshr_b32 s51, s2, 3
    s_lshl_b32 s26, s50, 5
    s_add_u32 s26, s26, s51
    s_lshr_b32 s21, s26, 3
    s_and_b32 s22, s26, 7
    v_lshlrev_b32 v2, 4, v1
    v_and_b32 v3, 15, v1
    v_lshrrev_b32 v4, 4, v1
    s_lshr_b32 s52, s22, 1
    s_and_b32 s53, s21, 3
    s_mov_b32 s15, 0x00020000
    s_cmp_lt_u32 s20, 5
    s_cbranch_scc1 L_mega_p0wq
    s_sub_u32 s60, s20, 5
    v_xor_b32 v5, v3, v4
    v_mul_u32_u24 v6, 1280, v4
    v_lshl_add_u32 v228, v5, 4, v6
    v_xor_b32 v7, 4, v5
    v_lshl_add_u32 v7, v7, 4, v6
    v_add_u32 v229, 5120, v7
    v_xor_b32 v7, 8, v5
    v_lshl_add_u32 v7, v7, 4, v6
    v_add_u32 v230, 10240, v7
    v_xor_b32 v7, 12, v5
    v_lshl_add_u32 v7, v7, 4, v6
    v_add_u32 v231, 15360, v7
    s_lshl_b32 s54, s21, 2
    s_add_u32 s55, s54, s52
    s_mul_i32 s55, s55, 20480
    s_add_u32 s56, s60, s53
    s_sub_u32 s57, s56, 5
    s_min_u32 s56, s56, s57
    s_add_u32 s57, s56, 3
    s_sub_u32 s58, s56, 2
    s_min_u32 s57, s57, s58
    s_lshl_b32 s56, s56, 8
    s_add_u32 s56, s56, s55
    s_lshl_b32 s57, s57, 8
    s_add_u32 s57, s57, s55
    s_lshl_b32 s58, s60, 14
    s_lshl_b32 s59, s52, 12
    s_add_u32 s58, s58, s59
    s_mov_b32 s14, 2621440
    s_waitcnt lgkmcnt(0)
    s_mov_b64 s[12:13], s[28:29]
    s_add_u32 m0, s58, 0
    s_nop 0
    buffer_load_dwordx4 v228, s[12:15], s56 offen lds
    s_add_u32 m0, s58, 1024
    s_nop 0
    buffer_load_dwordx4 v229, s[12:15], s56 offen lds
    s_add_u32 m0, s58, 2048
    s_nop 0
    buffer_load_dwordx4 v230, s[12:15], s56 offen lds
    s_add_u32 m0, s58, 3072
    s_nop 0
    buffer_load_dwordx4 v231, s[12:15], s56 offen lds
    s_cmp_eq_u32 s60, 2
    s_cbranch_scc1 L_sequ_x2_2
    s_add_u32 m0, s58, 49152
    s_nop 0
    buffer_load_dwordx4 v228, s[12:15], s57 offen lds
    s_add_u32 m0, s58, 50176
    s_nop 0
    buffer_load_dwordx4 v229, s[12:15], s57 offen lds
    s_add_u32 m0, s58, 51200
    s_nop 0
    buffer_load_dwordx4 v230, s[12:15], s57 offen lds
    s_add_u32 m0, s58, 52224
    s_nop 0
    buffer_load_dwordx4 v231, s[12:15], s57 offen lds
L_sequ_x2_2:
    s_cmp_ge_u32 s60, s52
    s_addc_u32 s56, s60, 0
    s_lshl_b32 s63, s56, 12
    s_add_u32 s56, s56, s54
    s_mul_i32 s56, s56, 20480
    s_movk_i32 s67, 256
    s_mov_b64 s[16:17], s[32:33]
    s_mov_b32 s18, 0
    s_mov_b32 s19, 0x00020000
    s_branch L_mega_p0i
L_mega_p0wq:
    s_mov_b32 s54, s20
    s_mov_b32 s18, 25600
    s_mov_b32 s19, 0x00020000
    s_mov_b32 s14, 819200
    s_mul_i32 s50, s20, 5120
    s_add_u32 m0, s50, 81920
    s_add_u32 s50, s20, s53
    s_sub_u32 s51, s50, 5
    s_min_u32 s50, s50, s51
    s_mul_i32 s50, s50, 5120
    s_bitcmp1_b32 s22, 0
    s_waitcnt lgkmcnt(0)
    s_cselect_b64 s[16:17], s[34:35], s[32:33]
    s_mov_b64 s[12:13], s[30:31]
    buffer_load_dwordx4 v2, s[16:19], s50 offen offset:0 lds
    buffer_load_dwordx4 v2, s[16:19], s50 offen offset:1024 lds
    buffer_load_dwordx4 v2, s[16:19], s50 offen offset:2048 lds
    buffer_load_dwordx4 v2, s[16:19], s50 offen offset:3072 lds
    s_add_u32 m0, m0, 4096
    s_add_u32 s50, s50, 4096
    buffer_load_dwordx4 v2, s[16:19], s50 offen lds
    s_lshl_b32 s55, s54, 6
    v_add_u32 v5, s55, v1
    v_mul_u32_u24 v6, 1639, v5
    v_lshrrev_b32 v6, 14, v6
    v_mul_u32_u24 v7, 10, v6
    v_sub_u32 v5, v5, v7
    v_and_b32 v7, 19, v6
    v_bfe_u32 v8, v6, 2, 1
    v_lshl_or_b32 v7, v8, 3, v7
    v_bfe_u32 v8, v6, 3, 1
    v_lshl_or_b32 v7, v8, 2, v7
    v_mul_u32_u24 v7, 1280, v7
    v_lshl_add_u32 v228, v5, 4, v7
    v_add_u32 v229, 40960, v228
    v_add_u32 v230, 81920, v228
    v_add_u32 v231, 122880, v228
    s_lshl_b32 s63, s54, 10
    s_add_u32 s63, s63, 81920
    s_mul_i32 s56, s22, 160
    s_mov_b32 s67, 163840
L_mega_p0i:
    s_mov_b32 s35, s53
    s_mul_i32 s77, s67, 5
    s_add_u32 s76, s56, s77
    s_mul_i32 s66, s67, s35
    s_add_u32 s66, s66, s56
    s_mov_b64 s[4:5], s[46:47]
    s_mov_b32 s6, 23068672
    s_mov_b32 s7, 0x00020000
    s_mov_b32 s50, 22554624
    s_load_dword s3, s[46:47], s50
    s_barrier
    s_mov_b64 s[8:9], s[46:47]
    s_mov_b32 s10, 0
    s_mov_b32 s11, 0x00020000
    v_mov_b32 v26, 0
    v_mov_b32 v27, -1
    v_mov_b32 v20, -1
    v_mov_b32 v21, -1
    v_mov_b32 v24, -1
    v_mov_b32 v25, -1
    s_mov_b32 s81, 0x30000
    s_mov_b64 s[68:69], 0
    s_mov_b64 s[70:71], 0
    s_mov_b64 s[72:73], 0
    s_mov_b64 s[74:75], 0
    s_and_b32 s23, s20, 3
    s_lshr_b32 s24, s20, 2
    v_mov_b32 v120, 0x3f803f80
    v_mov_b32 v121, 0x3f803f80
    v_mov_b32 v122, 0x3f803f80
    v_mov_b32 v123, 0x3f803f80
    v_xor_b32 v5, v4, v3
    v_lshlrev_b32 v5, 4, v5
    v_lshl_add_u32 v5, v3, 8, v5
    s_lshr_b32 s50, s22, 1
    s_lshl_b32 s50, s50, 12
    s_lshl_b32 s51, s23, 6
    s_lshl_b32 s52, s23, 12
    v_xor_b32 v6, s51, v5
    v_add_u32 v240, s50, v6
    v_add_u32 v241, 65536, v240
    v_add_u32 v6, s52, v6
    v_xor_b32 v232, 0, v6
    v_xor_b32 v233, 64, v6
    v_xor_b32 v234, 128, v6
    v_xor_b32 v235, 192, v6
    v_bfe_u32 v7, v1, 2, 2
    v_and_b32 v8, 3, v1
    v_bfe_u32 v9, v1, 2, 3
    v_lshrrev_b32 v10, 5, v1
    v_lshl_add_u32 v9, v10, 4, v9
    v_mul_u32_u24 v9, 160, v9
    v_lshl_add_u32 v9, v8, 3, v9
    s_mul_i32 s51, s24, 96
    s_add_u32 s51, s51, 81920
    s_xor_b32 s52, s23, 0
    s_mul_i32 s52, s52, 5120
    s_add_u32 s52, s52, s51
    v_add_u32 v236, s52, v9
    s_xor_b32 s52, s23, 1
    s_mul_i32 s52, s52, 5120
    s_add_u32 s52, s52, s51
    v_add_u32 v237, s52, v9
    s_xor_b32 s52, s23, 2
    s_mul_i32 s52, s52, 5120
    s_add_u32 s52, s52, s51
    v_add_u32 v238, s52, v9
    s_xor_b32 s52, s23, 3
    s_mul_i32 s52, s52, 5120
    s_add_u32 s52, s52, s51
    v_add_u32 v239, s52, v9
    v_lshl_add_u32 v7, v4, 3, v7
    v_mul_u32_u24 v7, 40, v7
    v_lshl_add_u32 v7, v8, 3, v7
    s_mul_i32 s51, s23, 1280
    s_add_u32 s51, s51, 81920
    v_add_u32 v244, s51, v7
    s_cmp_ge_u32 s20, 5
    s_cbranch_scc1 L_sequ_o5_3
    s_mul_i32 s50, s26, 5
    s_add_u32 s50, s50, s20
    s_cmp_ge_u32 s50, 200
    s_cbranch_scc1 L_sequ_rp1_4
    s_mov_b64 s[8:9], s[48:49]
    s_mov_b32 s10, 819200
    s_mov_b32 s56, 102400
    s_mov_b32 s57, 15728640
    s_mov_b32 s58, 0
    s_mov_b32 s59, 10
    s_branch L_sequ_rp2_5
L_sequ_rp1_4:
    s_mov_b32 s10, 2211840
    s_cmp_lt_u32 s50, 740
    s_cbranch_scc1 L_sequ_rpd_6w1
    s_sub_u32 s50, s50, 740
    s_mov_b64 s[8:9], s[40:41]
    s_mov_b32 s56, 276480
    s_mov_b32 s57, 19922944
    s_mov_b32 s58, 40
    s_mov_b32 s59, 27
L_sequ_rp2_5:
    s_mul_i32 s51, s50, 1639
    s_lshr_b32 s51, s51, 14
    s_mul_i32 s52, s51, 10
    s_movk_i32 s53, 1280
    s_mov_b32 s54, 5
    s_movk_i32 s55, 206
    s_branch L_sequ_rpd_6
L_sequ_rpd_6w1:
    s_sub_u32 s50, s50, 200
    s_mov_b64 s[8:9], s[36:37]
    s_mov_b32 s56, 143360
    s_mov_b32 s57, 16777216
    s_mov_b32 s58, 20
    s_movk_i32 s59, 99
    s_mul_i32 s51, s50, 607
    s_lshr_b32 s51, s51, 14
    s_mul_i32 s52, s51, 27
    s_movk_i32 s53, 3456
    s_mov_b32 s54, 7
    s_movk_i32 s55, 147
L_sequ_rpd_6:
    s_sub_u32 s52, s50, s52
    s_mul_i32 s19, s51, 7168
    s_lshl_b32 s62, s52, 8
    s_add_u32 s19, s19, s62
    s_add_u32 s19, s19, 22282240
    s_cmp_eq_u32 s54, 7
    s_cselect_b32 s19, s19, 0x7f000000
    s_add_u32 s58, s58, s51
    s_lshl_b32 s58, s58, 5
    s_getpc_b64 s[60:61]
L_sequ_pc_7:
    s_add_u32 s60, s60, L_mega_tab-L_sequ_pc_7
    s_addc_u32 s61, s61, 0
    s_load_dwordx8 s[68:75], s[60:61], s58
    v_bfe_u32 v5, v1, 3, 2
    v_mul_u32_u24 v5, s53, v5
    v_and_b32 v6, 7, v1
    v_lshl_add_u32 v5, v6, 4, v5
    s_lshl_b32 s62, s52, 7
    v_add_u32 v26, s62, v5
    s_lshl_b32 s62, s52, 2
    v_add_u32 v5, s62, v4
    v_mul_u32_u24 v6, s55, v5
    v_lshrrev_b32 v6, 10, v6
    v_cmp_eq_u32 vcc, 107, v5
    v_mul_u32_u24 v7, s54, v6
    v_sub_u32 v5, v5, v7
    v_cndmask_b32 v5, v5, 6, vcc
    s_cmp_ge_u32 s51, s59
    s_cselect_b32 s62, 2, 0
    v_cmp_gt_u32 vcc, 4, v5
    v_xor_b32 v7, s62, v5
    v_mul_lo_u32 v6, v6, s56
    v_cndmask_b32 v5, v5, v7, vcc
    v_lshl_add_u32 v5, v5, 10, v6
    v_lshl_add_u32 v5, v3, 4, v5
    s_lshl_b32 s62, s51, 1
    s_sub_u32 s58, s62, 53
    s_min_u32 s62, s62, s58
    s_cmp_eq_u32 s59, 27
    s_cselect_b32 s51, s62, s51
    s_mul_i32 s62, s51, s54
    s_lshl_b32 s62, s62, 10
    s_add_u32 s62, s62, s57
    v_add_u32 v27, s62, v5
    s_lshr_b32 s81, s20, 1
    s_lshl_b32 s81, s81, 15
    s_and_b32 s62, s20, 1
    s_lshl_b32 s62, s62, 12
    s_add_u32 s81, s81, s62
    s_add_u32 s81, s81, 24576
    s_cmp_eq_u32 s20, 4
    s_cselect_b32 s81, 102400, s81
    v_bfe_u32 v5, v1, 2, 2
    v_lshlrev_b32 v5, 7, v5
    v_lshl_add_u32 v5, v4, 5, v5
    v_and_b32 v6, 3, v1
    v_lshl_add_u32 v5, v6, 3, v5
    v_add_u32 v28, s81, v5
L_sequ_o5_3:
    s_cmp_lt_u32 s20, 5
    s_cbranch_scc1 L_sequ_bw_8
    s_add_u32 m0, s63, 0
    s_nop 0
    buffer_load_dwordx4 v228, s[12:15], s66 offen lds
    s_add_u32 m0, s63, 1024
    s_nop 0
    buffer_load_dwordx4 v229, s[12:15], s66 offen lds
    s_add_u32 m0, s63, 2048
    s_nop 0
    buffer_load_dwordx4 v230, s[12:15], s66 offen lds
    s_add_u32 m0, s63, 3072
    s_nop 0
    buffer_load_dwordx4 v231, s[12:15], s66 offen lds
    s_branch L_sequ_bj_9
L_sequ_bw_8:
    s_add_u32 m0, s63, 40960
    s_nop 0
    buffer_load_dwordx4 v228, s[12:15], s66 offen lds
    s_add_u32 m0, s63, 46080
    s_nop 0
    buffer_load_dwordx4 v229, s[12:15], s66 offen lds
    s_add_u32 m0, s63, 51200
    s_nop 0
    buffer_load_dwordx4 v230, s[12:15], s66 offen lds
    s_add_u32 m0, s63, 56320
    s_nop 0
    buffer_load_dwordx4 v231, s[12:15], s66 offen lds
L_sequ_bj_9:
    s_add_u32 s66, s66, s67
    s_sub_u32 s64, s66, s77
    s_cmp_ge_u32 s66, s76
    s_cselect_b32 s66, s64, s66
    s_waitcnt vmcnt(4)
    s_waitcnt lgkmcnt(0)
    s_barrier
    s_lshr_b32 s3, s3, 3
    s_mul_i32 s3, s3, 0x41c64e6d
    s_add_u32 s3, s3, 12345
    s_lshl_b32 s3, s3, 3
    s_getreg_b32 s34, hwreg(HW_REG_XCC_ID, 0, 3)
    s_or_b32 s34, s34, s3
    s_mul_i32 s50, s20, 2304
    s_cmp_lt_u32 s20, 4
    s_cselect_b32 s50, s50, 0
    s_add_u32 s50, s50, 107520
    s_cmp_lg_u32 s24, 0
    s_cbranch_scc1 L_sequ_kh_10
    ds_read_b128 v[126:129], v240 offset:0
    ds_read_b64_tr_b16 v[130:131], v244 offset:0
    ds_read_b64_tr_b16 v[132:133], v244 offset:160
    ds_read_b64_tr_b16 v[134:135], v244 offset:8
    ds_read_b64_tr_b16 v[136:137], v244 offset:168
    ds_read_b128 v[138:141], v240 offset:16384
    ds_read_b64_tr_b16 v[142:143], v244 offset:5120
    ds_read_b64_tr_b16 v[144:145], v244 offset:5280
    ds_read_b64_tr_b16 v[146:147], v244 offset:5128
    ds_read_b64_tr_b16 v[148:149], v244 offset:5288
    ds_read_b128 v[150:153], v240 offset:32768
    ds_read_b64_tr_b16 v[154:155], v244 offset:10240
    ds_read_b64_tr_b16 v[156:157], v244 offset:10400
    ds_read_b64_tr_b16 v[158:159], v244 offset:10248
    ds_read_b64_tr_b16 v[160:161], v244 offset:10408
    ds_read_b128 v[162:165], v240 offset:49152
    ds_read_b64_tr_b16 v[166:167], v244 offset:15360
    ds_read_b64_tr_b16 v[168:169], v244 offset:15520
    ds_read_b64_tr_b16 v[170:171], v244 offset:15368
    ds_read_b64_tr_b16 v[172:173], v244 offset:15528
    ds_read_b128 v[174:177], v241 offset:0
    ds_read_b64_tr_b16 v[178:179], v244 offset:20480
    ds_read_b64_tr_b16 v[180:181], v244 offset:20640
    ds_read_b64_tr_b16 v[182:183], v244 offset:20488
    ds_read_b64_tr_b16 v[184:185], v244 offset:20648
L_sequ_kh_10:
    v_add_u32 v242, s50, v2
    v_lshl_add_u32 v243, v4, 4, s50
    v_lshl_add_u32 v245, v3, 3, s50
    s_cmp_lg_u32 s24, 0
    s_cbranch_scc1 L_sequ_kh_11
    s_waitcnt lgkmcnt(15)
    v_mfma_f32_16x16x32_bf16 v[190:193], v[120:123], v[126:129], 0
    v_mfma_f32_16x16x32_bf16 v[246:249], v[126:129], v[126:129], 0
    v_mfma_f32_16x16x32_bf16 v[106:109], v[130:133], v[120:123], 0
    v_mfma_f32_16x16x32_bf16 v[110:113], v[134:137], v[120:123], 0
    v_mfma_f32_16x16x32_bf16 v[94:97], v[130:133], v[126:129], 0
    v_mfma_f32_16x16x32_bf16 v[98:101], v[134:137], v[126:129], 0
    s_waitcnt lgkmcnt(15)
    v_mfma_f32_16x16x32_bf16 v[190:193], v[120:123], v[138:141], v[190:193]
    v_mfma_f32_16x16x32_bf16 v[246:249], v[138:141], v[138:141], v[246:249]
    v_mfma_f32_16x16x32_bf16 v[106:109], v[142:145], v[120:123], v[106:109]
    v_mfma_f32_16x16x32_bf16 v[110:113], v[146:149], v[120:123], v[110:113]
    v_mfma_f32_16x16x32_bf16 v[94:97], v[142:145], v[138:141], v[94:97]
    v_mfma_f32_16x16x32_bf16 v[98:101], v[146:149], v[138:141], v[98:101]
    s_waitcnt lgkmcnt(10)
    v_mfma_f32_16x16x32_bf16 v[190:193], v[120:123], v[150:153], v[190:193]
    v_mfma_f32_16x16x32_bf16 v[246:249], v[150:153], v[150:153], v[246:249]
    v_mfma_f32_16x16x32_bf16 v[106:109], v[154:157], v[120:123], v[106:109]
    v_mfma_f32_16x16x32_bf16 v[110:113], v[158:161], v[120:123], v[110:113]
    v_mfma_f32_16x16x32_bf16 v[94:97], v[154:157], v[150:153], v[94:97]
    v_mfma_f32_16x16x32_bf16 v[98:101], v[158:161], v[150:153], v[98:101]
    s_waitcnt lgkmcnt(5)
    v_mfma_f32_16x16x32_bf16 v[190:193], v[120:123], v[162:165], v[190:193]
    v_mfma_f32_16x16x32_bf16 v[246:249], v[162:165], v[162:165], v[246:249]
    v_mfma_f32_16x16x32_bf16 v[106:109], v[166:169], v[120:123], v[106:109]
    v_mfma_f32_16x16x32_bf16 v[110:113], v[170:173], v[120:123], v[110:113]
    v_mfma_f32_16x16x32_bf16 v[94:97], v[166:169], v[162:165], v[94:97]
    v_mfma_f32_16x16x32_bf16 v[98:101], v[170:173], v[162:165], v[98:101]
    s_waitcnt lgkmcnt(0)
    v_mfma_f32_16x16x32_bf16 v[190:193], v[120:123], v[174:177], v[190:193]
    v_mfma_f32_16x16x32_bf16 v[246:249], v[174:177], v[174:177], v[246:249]
    v_mfma_f32_16x16x32_bf16 v[106:109], v[178:181], v[120:123], v[106:109]
    v_mfma_f32_16x16x32_bf16 v[110:113], v[182:185], v[120:123], v[110:113]
    v_mfma_f32_16x16x32_bf16 v[94:97], v[178:181], v[174:177], v[94:97]
    v_mfma_f32_16x16x32_bf16 v[98:101], v[182:185], v[174:177], v[98:101]
    s_nop 2
    v_mov_b32 v118, v190
    s_mov_b32 vcc_lo, 0x22222222
    s_mov_b32 vcc_hi, 0x22222222
    v_cndmask_b32 v119, v246, v247, vcc
    s_mov_b32 vcc_lo, 0x44444444
    s_mov_b32 vcc_hi, 0x44444444
    v_cndmask_b32 v119, v119, v248, vcc
    s_mov_b32 vcc_lo, 0x88888888
    s_mov_b32 vcc_hi, 0x88888888
    v_cndmask_b32 v119, v119, v249, vcc
    s_mov_b32 exec_lo, 0x00f0000f
    s_mov_b32 exec_hi, 0xf0000f00
    ds_write_b64 v245, v[118:119] offset:2176
    s_mov_b64 exec, -1
    ds_write_b128 v243, v[106:109] offset:2048
    ds_write_b128 v243, v[110:113] offset:2112
    ds_write_b128 v242, v[94:97] offset:0
    ds_write_b128 v242, v[98:101] offset:1024
L_sequ_kh_11:
    s_cmp_lg_u32 s24, 1
    s_cbranch_scc1 L_sequ_kh_12
    s_lshl_b32 s25, s22, 2
    s_add_u32 s25, s25, s23
    s_lshl_b32 s30, s24, 15
    s_lshl_b32 s52, s23, 10
    s_add_u32 s30, s30, s52
    s_mul_i32 s31, s24, 43008
    s_add_u32 s31, s31, 65536
    s_add_u32 s31, s31, s52
    s_lshl_b32 s33, s24, 13
    s_add_u32 s33, s33, 2785280
    s_add_u32 s33, s33, s52
    s_add_u32 s33, s33, s52
    s_add_u32 s32, s30, s52
    v_lshrrev_b32 v5, 1, v4
    v_xor_b32 v5, v5, v3
    v_lshlrev_b32 v5, 4, v5
    v_and_b32 v6, 1, v4
    v_lshl_add_u32 v5, v6, 3, v5
    v_lshl_add_u32 v5, v3, 8, v5
    s_mul_i32 s53, s22, 160
    s_lshl_b32 s54, s24, 6
    s_add_u32 s54, s54, s53
    s_lshl_b32 s58, s23, 12
    s_add_u32 s55, s54, 0
    s_lshr_b32 s56, s55, 8
    s_sub_u32 s56, s56, s35
    s_add_u32 s57, s56, 5
    s_min_u32 s56, s56, s57
    s_lshl_b32 s56, s56, 14
    s_add_u32 s56, s56, s58
    s_and_b32 s55, s55, 255
    v_xor_b32 v14, s55, v5
    v_add_u32 v14, s56, v14
    s_add_u32 s55, s54, 32
    s_lshr_b32 s56, s55, 8
    s_sub_u32 s56, s56, s35
    s_add_u32 s57, s56, 5
    s_min_u32 s56, s56, s57
    s_lshl_b32 s56, s56, 14
    s_add_u32 s56, s56, s58
    s_and_b32 s55, s55, 255
    v_xor_b32 v16, s55, v5
    v_add_u32 v16, s56, v16
    s_add_u32 s55, s53, 128
    s_lshr_b32 s56, s55, 8
    s_sub_u32 s56, s56, s35
    s_add_u32 s57, s56, 5
    s_min_u32 s56, s56, s57
    s_lshl_b32 s56, s56, 14
    s_add_u32 s56, s56, s58
    s_and_b32 s55, s55, 255
    v_xor_b32 v18, s55, v5
    v_add_u32 v18, s56, v18
    s_lshl_b32 s50, s24, 15
    v_add_u32 v20, s50, v2
    v_and_b32 v5, 31, v1
    v_min_u32 v5, 20, v5
    v_lshlrev_b32 v5, 4, v5
    v_lshrrev_b32 v6, 5, v1
    v_mul_u32_u24 v8, 336, v6
    s_mul_i32 s50, s24, 43008
    s_add_u32 s50, s50, 65536
    v_add3_u32 v21, v5, v8, s50
    s_mov_b32 vcc_lo, 0xffe00000
    s_mov_b32 vcc_hi, 0xffe00000
    v_mov_b32 v5, 0x40000
    v_cndmask_b32 v21, v21, v5, vcc
    s_lshl_b32 s79, s21, 2
    s_add_u32 s79, s79, s23
    s_lshr_b32 s80, s26, 4
    s_and_b32 s27, s26, 15
    s_lshl_b32 s50, s21, 2
    s_lshl_b32 s51, s24, 1
    s_add_u32 s50, s50, s51
    s_mul_i32 s50, s50, 20480
    s_add_u32 s50, s50, 3145728
    s_lshr_b32 s51, s25, 1
    s_mul_i32 s51, s51, 1280
    s_add_u32 s50, s50, s51
    s_and_b32 s51, s25, 1
    s_lshl_b32 s52, s51, 9
    s_add_u32 s52, s52, s50
    s_lshl_b32 s51, s51, 3
    s_add_u32 s51, s51, s50
    s_add_u32 s51, s51, 1024
    v_and_b32 v5, 1, v4
    v_mul_u32_u24 v5, 20480, v5
    v_lshl_add_u32 v5, v3, 4, v5
    v_add_u32 v25, s51, v5
    v_lshl_add_u32 v5, v6, 8, v5
    v_add_u32 v24, s52, v5
    s_mul_i32 s50, s24, 192
    s_add_u32 s50, s50, 143360
    v_lshl_add_u32 v250, v4, 4, s50
    s_mul_i32 s51, s23, 384
    v_add_u32 v251, s51, v250
    s_lshl_b32 s50, s23, 7
    s_add_u32 s50, s50, 144896
    v_lshl_add_u32 v252, v3, 3, s50
    s_lshl_b32 s51, s24, 9
    v_add_u32 v253, s51, v252
    s_lshl_b32 s50, s23, 4
    v_add_u32 v254, s50, v3
    v_mul_u32_u24 v254, 176, v254
    s_mul_i32 s50, s24, 96
    s_add_u32 s50, s50, 151552
    v_lshl_add_u32 v254, v4, 3, v254
    v_add_u32 v254, s50, v254
    s_mul_i32 s50, s23, 40
    s_add_u32 s50, s50, 151552
    v_and_b32 v255, 31, v1
    v_mul_u32_u24 v255, 176, v255
    v_lshrrev_b32 v200, 5, v1
    v_lshl_add_u32 v255, v200, 4, v255
    v_add_u32 v255, s50, v255
    v_mul_u32_u24 v200, 176, v1
    v_add_u32 v200, s50, v200
    s_lshl_b32 s50, s23, 10
    s_add_u32 s28, s30, s50
    s_add_u32 s29, s28, s50
    s_add_u32 s53, s29, s50
    s_add_u32 s54, s31, s50
    s_add_u32 s55, s54, s50
    s_add_u32 s56, s55, s50
    s_mul_i32 s50, s22, 102400
    s_add_u32 s50, s50, 15728640
    s_mul_i32 s51, s24, 18432
    s_add_u32 s57, s50, s51
    s_mul_i32 s51, s24, 8192
    s_add_u32 s58, s50, s51
    s_sub_u32 s58, s58, 45056
    s_mul_i32 s51, s24, 45056
    s_add_u32 s60, s50, s51
    s_sub_u32 s60, s60, 106496
    s_min_u32 s50, s23, 2
    s_lshl_b32 s50, s50, 11
    s_mul_i32 s51, s24, 6144
    s_add_u32 s59, s50, s51
    s_and_b32 s50, s26, 31
    s_lshl_b32 s50, s50, 3
    s_add_u32 s50, s50, s20
    s_lshl_b32 s61, s50, 11
    s_and_b32 s50, s21, 3
    s_lshl_b32 s50, s50, 3
    s_add_u32 s50, s50, s20
    s_lshl_b32 s50, s50, 11
    s_mul_i32 s62, s22, 276480
    s_add_u32 s62, s62, s50
L_sequ_kh_12:
    s_cmp_lt_u32 s20, 5
    s_cbranch_scc1 L_sequ_bw_13
    s_add_u32 m0, s63, 16384
    s_nop 0
    buffer_load_dwordx4 v228, s[12:15], s66 offen lds
    s_add_u32 m0, s63, 17408
    s_nop 0
    buffer_load_dwordx4 v229, s[12:15], s66 offen lds
    s_add_u32 m0, s63, 18432
    s_nop 0
    buffer_load_dwordx4 v230, s[12:15], s66 offen lds
    s_add_u32 m0, s63, 19456
    s_nop 0
    buffer_load_dwordx4 v231, s[12:15], s66 offen lds
    s_branch L_sequ_bj_14
L_sequ_bw_13:
    s_add_u32 m0, s63, 61440
    s_nop 0
    buffer_load_dwordx4 v228, s[12:15], s66 offen lds
    s_add_u32 m0, s63, 66560
    s_nop 0
    buffer_load_dwordx4 v229, s[12:15], s66 offen lds
    s_add_u32 m0, s63, 71680
    s_nop 0
    buffer_load_dwordx4 v230, s[12:15], s66 offen lds
    s_add_u32 m0, s63, 76800
    s_nop 0
    buffer_load_dwordx4 v231, s[12:15], s66 offen lds
L_sequ_bj_14:
    s_add_u32 s66, s66, s67
    s_sub_u32 s64, s66, s77
    s_cmp_ge_u32 s66, s76
    s_cselect_b32 s66, s64, s66
    s_waitcnt vmcnt(4)
    s_waitcnt lgkmcnt(0)
    s_barrier
    s_cmp_lg_u32 s20, 7
    s_cbranch_scc1 L_sequ_w7_15
    s_setprio 3
    ds_read_b64 v[212:213], v245 offset:2176
    ds_read_b64 v[214:215], v245 offset:4480
    ds_read_b64 v[216:217], v245 offset:6784
    ds_read_b64 v[218:219], v245 offset:9088
    ds_read_b128 v[158:161], v243 offset:2048
    ds_read_b128 v[162:165], v243 offset:2112
    ds_read_b128 v[166:169], v243 offset:4352
    ds_read_b128 v[170:173], v243 offset:4416
    ds_read_b128 v[174:177], v243 offset:6656
    ds_read_b128 v[178:181], v243 offset:6720
    ds_read_b128 v[182:185], v243 offset:8960
    ds_read_b128 v[186:189], v243 offset:9024
    s_waitcnt lgkmcnt(8)
    ds_read_b128 v[126:129], v242 offset:0
    ds_read_b128 v[130:133], v242 offset:1024
    ds_read_b128 v[134:137], v242 offset:2304
    ds_read_b128 v[138:141], v242 offset:3328
    ds_read_b128 v[142:145], v242 offset:4608
    ds_read_b128 v[146:149], v242 offset:5632
    ds_read_b128 v[150:153], v242 offset:6912
    ds_read_b128 v[154:157], v242 offset:7936
    v_pk_add_f32 v[212:213], v[212:213], v[214:215]
    v_pk_add_f32 v[212:213], v[212:213], v[216:217]
    v_pk_add_f32 v[212:213], v[212:213], v[218:219]
    v_mul_f32 v222, 0x3acccccd, v212
    v_mul_f32 v213, 0x3acccccd, v213
    v_fma_f32 v213, -v222, v222, v213
    v_max_f32 v213, 0, v213
    v_cvt_pk_bf16_f32 v213, v222, v213
    v_lshlrev_b32 v222, 16, v213
    v_and_b32 v213, 0xffff0000, v213
    v_add_f32 v213, 0x3727c5ac, v213
    v_cvt_pk_bf16_f32 v213, 0, v213
    v_sqrt_f32 v213, v213
    v_mov_b32 v223, v222
    v_cvt_pk_bf16_f32 v213, 0, v213
    v_rcp_f32 v224, v213
    s_nop 0
    v_mov_b32 v225, v224
    s_waitcnt lgkmcnt(8)
    v_pk_add_f32 v[158:159], v[158:159], v[166:167]
    v_pk_add_f32 v[160:161], v[160:161], v[168:169]
    v_pk_add_f32 v[162:163], v[162:163], v[170:171]
    v_pk_add_f32 v[164:165], v[164:165], v[172:173]
    v_pk_add_f32 v[158:159], v[158:159], v[174:175]
    v_pk_add_f32 v[160:161], v[160:161], v[176:177]
    v_pk_add_f32 v[162:163], v[162:163], v[178:179]
    v_pk_add_f32 v[164:165], v[164:165], v[180:181]
    v_pk_add_f32 v[158:159], v[158:159], v[182:183]
    v_pk_add_f32 v[160:161], v[160:161], v[184:185]
    v_pk_add_f32 v[162:163], v[162:163], v[186:187]
    v_pk_add_f32 v[164:165], v[164:165], v[188:189]
    s_waitcnt lgkmcnt(0)
    v_pk_add_f32 v[126:127], v[126:127], v[134:135]
    v_pk_add_f32 v[128:129], v[128:129], v[136:137]
    v_pk_add_f32 v[130:131], v[130:131], v[138:139]
    v_pk_add_f32 v[132:133], v[132:133], v[140:141]
    v_pk_add_f32 v[126:127], v[126:127], v[142:143]
    v_pk_add_f32 v[128:129], v[128:129], v[144:145]
    v_pk_add_f32 v[130:131], v[130:131], v[146:147]
    v_pk_add_f32 v[132:133], v[132:133], v[148:149]
    v_pk_add_f32 v[126:127], v[126:127], v[150:151]
    v_pk_add_f32 v[128:129], v[128:129], v[152:153]
    v_pk_add_f32 v[130:131], v[130:131], v[154:155]
    v_pk_add_f32 v[132:133], v[132:133], v[156:157]
    v_pk_fma_f32 v[126:127], v[222:223], v[158:159], v[126:127] neg_lo:[1,0,0] neg_hi:[1,0,0]
    v_pk_fma_f32 v[128:129], v[222:223], v[160:161], v[128:129] neg_lo:[1,0,0] neg_hi:[1,0,0]
    v_pk_mul_f32 v[126:127], v[126:127], v[224:225]
    v_pk_mul_f32 v[128:129], v[128:129], v[224:225]
    v_cvt_pk_bf16_f32 v140, v126, v127
    v_cvt_pk_bf16_f32 v141, v128, v129
    v_pk_fma_f32 v[130:131], v[222:223], v[162:163], v[130:131] neg_lo:[1,0,0] neg_hi:[1,0,0]
    v_pk_fma_f32 v[132:133], v[222:223], v[164:165], v[132:133] neg_lo:[1,0,0] neg_hi:[1,0,0]
    v_pk_mul_f32 v[130:131], v[130:131], v[224:225]
    v_pk_mul_f32 v[132:133], v[132:133], v[224:225]
    v_cvt_pk_bf16_f32 v142, v130, v131
    v_cvt_pk_bf16_f32 v143, v132, v133
    s_waitcnt vmcnt(0)
    s_lshl_b32 s50, s21, 2
    s_lshr_b32 s51, s22, 1
    s_add_u32 s50, s50, s51
    s_bitcmp1_b32 s22, 0
    s_cbranch_scc1 L_sequ_kvV_16
    v_mov_b32 v152, v140
    v_mov_b32 v153, v141
    v_mov_b32 v148, v140
    v_mov_b32 v149, v141
    v_lshrrev_b32 v5, 1, v4
    v_lshlrev_b32 v5, 9, v5
    v_lshl_add_u32 v5, v3, 4, v5
    v_permlane16_swap_b32 v152, v150
    v_permlane16_swap_b32 v153, v151
    s_lshr_b32 s51, s50, 1
    s_lshl_b32 s51, s51, 10
    s_and_b32 s52, s50, 1
    s_lshl_b32 s52, s52, 8
    s_add_u32 s51, s51, s52
    s_add_u32 s51, s51, 2621440
    s_mov_b32 exec_lo, 0xffff
    s_mov_b32 exec_hi, 0xffff
    buffer_store_dwordx4 v[148:151], v5, s[4:7], s51 offen sc1
    s_lshr_b32 s51, s50, 3
    s_lshl_b32 s51, s51, 10
    s_and_b32 s52, s50, 3
    s_lshl_b32 s52, s52, 8
    s_add_u32 s51, s51, s52
    s_and_b32 s52, s50, 4
    s_lshl_b32 s52, s52, 1
    s_add_u32 s51, s51, s52
    s_add_u32 s51, s51, 2784512
    s_mov_b32 exec_lo, 0
    s_mov_b32 exec_hi, 0xffff0000
    buffer_store_dwordx2 v[142:143], v2, s[4:7], s51 offen sc1
    s_branch L_sequ_kvE_17
L_sequ_kvV_16:
    v_bfe_u32 v5, v3, 2, 1
    v_mul_u32_u24 v5, 336, v5
    v_lshrrev_b32 v6, 3, v3
    v_lshl_add_u32 v5, v6, 3, v5
    v_and_b32 v6, 3, v3
    v_lshl_add_u32 v5, v6, 1, v5
    v_add_u32 v5, 119808, v5
    ds_write_b16 v5, v120 offset:320
    v_lshl_add_u32 v5, v4, 6, v5
    ds_write_b16 v5, v140 offset:0
    ds_write_b16_d16_hi v5, v140 offset:16
    ds_write_b16 v5, v141 offset:32
    ds_write_b16_d16_hi v5, v141 offset:48
    ds_write_b16 v5, v142 offset:64
    ds_write_b16_d16_hi v5, v142 offset:80
    ds_write_b16 v5, v143 offset:96
    ds_write_b16_d16_hi v5, v143 offset:112
    v_add_u32 v6, 119808, v2
    s_mul_i32 s51, s50, 672
    s_add_u32 s51, s51, 2686976
    s_waitcnt lgkmcnt(0)
    ds_read_b128 v[148:151], v6
    s_mov_b32 exec_hi, 0x3ff
    s_waitcnt lgkmcnt(0)
    buffer_store_dwordx4 v[148:151], v2, s[4:7], s51 offen sc1
L_sequ_kvE_17:
    s_mov_b64 exec, -1
L_sequ_w7_15:
    s_cmp_lt_u32 s20, 5
    s_movk_i32 s78, 1024
    s_cselect_b32 s78, 5120, s78
    s_mov_b32 s16, 49152
    s_cselect_b32 s16, 20480, s16
    s_mov_b32 s17, 65536
    s_cselect_b32 s17, 40960, s17
    s_add_u32 s16, s16, s63
    s_add_u32 s17, s17, s63
    s_cmp_eq_u32 s24, 1
    s_cbranch_scc1 L_sequ_qf1_18
    ds_read_b128 v[30:33], v232 offset:0
    ds_read_b64_tr_b16 v[34:35], v236 offset:40960
    ds_read_b64_tr_b16 v[36:37], v236 offset:42240
    ds_read_b64_tr_b16 v[38:39], v236 offset:40992
    ds_read_b64_tr_b16 v[40:41], v236 offset:42272
    ds_read_b64_tr_b16 v[42:43], v236 offset:41024
    ds_read_b64_tr_b16 v[44:45], v236 offset:42304
    ds_read_b128 v[46:49], v233 offset:0
    ds_read_b64_tr_b16 v[50:51], v237 offset:40960
    ds_read_b64_tr_b16 v[52:53], v237 offset:42240
    ds_read_b64_tr_b16 v[54:55], v237 offset:40992
    ds_read_b64_tr_b16 v[56:57], v237 offset:42272
    ds_read_b64_tr_b16 v[58:59], v237 offset:41024
    ds_read_b64_tr_b16 v[60:61], v237 offset:42304
    ds_read_b128 v[62:65], v234 offset:0
    ds_read_b64_tr_b16 v[66:67], v238 offset:40960
    ds_read_b64_tr_b16 v[68:69], v238 offset:42240
    ds_read_b64_tr_b16 v[70:71], v238 offset:40992
    ds_read_b64_tr_b16 v[72:73], v238 offset:42272
    ds_read_b64_tr_b16 v[74:75], v238 offset:41024
    ds_read_b64_tr_b16 v[76:77], v238 offset:42304
    ds_read_b128 v[78:81], v235 offset:0
    ds_read_b64_tr_b16 v[82:83], v239 offset:40960
    ds_read_b64_tr_b16 v[84:85], v239 offset:42240
    ds_read_b64_tr_b16 v[86:87], v239 offset:40992
    ds_read_b64_tr_b16 v[88:89], v239 offset:42272
    ds_read_b64_tr_b16 v[90:91], v239 offset:41024
    ds_read_b64_tr_b16 v[92:93], v239 offset:42304
    s_waitcnt vmcnt(0)
    s_cmp_lt_u32 s20, 5
    s_cbranch_scc1 L_sequ_bw_20
    s_add_u32 m0, s63, 32768
    s_nop 0
    buffer_load_dwordx4 v228, s[12:15], s66 offen lds
    s_add_u32 m0, s63, 33792
    s_nop 0
    buffer_load_dwordx4 v229, s[12:15], s66 offen lds
    s_add_u32 m0, s63, 34816
    s_nop 0
    buffer_load_dwordx4 v230, s[12:15], s66 offen lds
    s_add_u32 m0, s63, 35840
    s_nop 0
    buffer_load_dwordx4 v231, s[12:15], s66 offen lds
    s_branch L_sequ_bj_21
L_sequ_bw_20:
    s_add_u32 m0, s63, 0
    s_nop 0
    buffer_load_dwordx4 v228, s[12:15], s66 offen lds
    s_add_u32 m0, s63, 5120
    s_nop 0
    buffer_load_dwordx4 v229, s[12:15], s66 offen lds
    s_add_u32 m0, s63, 10240
    s_nop 0
    buffer_load_dwordx4 v230, s[12:15], s66 offen lds
    s_add_u32 m0, s63, 15360
    s_nop 0
    buffer_load_dwordx4 v231, s[12:15], s66 offen lds
L_sequ_bj_21:
    s_add_u32 s66, s66, s67
    s_sub_u32 s64, s66, s77
    s_cmp_ge_u32 s66, s76
    s_cselect_b32 s66, s64, s66
    s_waitcnt lgkmcnt(0)
    s_barrier
    s_setprio 3
    v_mfma_f32_16x16x32_bf16 v[94:97], v[34:37], v[30:33], 0
    ds_read_b128 v[126:129], v232 offset:16384
    ds_read_b64_tr_b16 v[130:131], v236 offset:61440
    s_lshl_b32 s25, s22, 2
    s_add_u32 s25, s25, s23
    s_lshl_b32 s30, s24, 15
    v_mfma_f32_16x16x32_bf16 v[106:109], v[34:37], v[120:123], 0
    ds_read_b64_tr_b16 v[132:133], v236 offset:62720
    ds_read_b64_tr_b16 v[134:135], v236 offset:61472
    s_lshl_b32 s52, s23, 10
    s_add_u32 s30, s30, s52
    s_mul_i32 s31, s24, 43008
    v_mfma_f32_16x16x32_bf16 v[98:101], v[38:41], v[30:33], 0
    ds_read_b64_tr_b16 v[136:137], v236 offset:62752
    ds_read_b64_tr_b16 v[138:139], v236 offset:61504
    s_add_u32 s31, s31, 65536
    s_add_u32 s31, s31, s52
    s_lshl_b32 s33, s24, 13
    v_mfma_f32_16x16x32_bf16 v[110:113], v[38:41], v[120:123], 0
    ds_read_b64_tr_b16 v[140:141], v236 offset:62784
    ds_read_b128 v[142:145], v233 offset:16384
    s_add_u32 s33, s33, 2785280
    s_add_u32 s33, s33, s52
    s_add_u32 s33, s33, s52
    v_mfma_f32_16x16x32_bf16 v[102:105], v[42:45], v[30:33], 0
    ds_read_b64_tr_b16 v[146:147], v237 offset:61440
    ds_read_b64_tr_b16 v[148:149], v237 offset:62720
    s_add_u32 s32, s30, s52
    v_lshrrev_b32 v5, 1, v4
    v_xor_b32 v5, v5, v3
    v_mfma_f32_16x16x32_bf16 v[114:117], v[42:45], v[120:123], 0
    ds_read_b64_tr_b16 v[150:151], v237 offset:61472
    ds_read_b64_tr_b16 v[152:153], v237 offset:62752
    v_lshlrev_b32 v5, 4, v5
    v_and_b32 v6, 1, v4
    v_lshl_add_u32 v5, v6, 3, v5
    s_setprio 2
    v_mfma_f32_16x16x32_bf16 v[94:97], v[50:53], v[46:49], v[94:97]
    ds_read_b64_tr_b16 v[154:155], v237 offset:61504
    ds_read_b64_tr_b16 v[156:157], v237 offset:62784
    s_mov_b32 m0, s16
    v_lshl_add_u32 v5, v3, 8, v5
    s_mul_i32 s53, s22, 160
    s_lshl_b32 s54, s24, 6
    v_mfma_f32_16x16x32_bf16 v[98:101], v[54:57], v[46:49], v[98:101]
    ds_read_b128 v[158:161], v234 offset:16384
    ds_read_b64_tr_b16 v[162:163], v238 offset:61440
    buffer_load_dwordx4 v228, s[12:15], s66 offen lds
    s_add_u32 s54, s54, s53
    s_lshl_b32 s58, s23, 12
    s_add_u32 s55, s54, 0
    v_mfma_f32_16x16x32_bf16 v[102:105], v[58:61], v[46:49], v[102:105]
    ds_read_b64_tr_b16 v[164:165], v238 offset:62720
    ds_read_b64_tr_b16 v[166:167], v238 offset:61472
    s_add_u32 m0, m0, s78
    s_lshr_b32 s56, s55, 8
    s_sub_u32 s56, s56, s35
    s_add_u32 s57, s56, 5
    v_mfma_f32_16x16x32_bf16 v[94:97], v[66:69], v[62:65], v[94:97]
    ds_read_b64_tr_b16 v[168:169], v238 offset:62752
    ds_read_b64_tr_b16 v[170:171], v238 offset:61504
    buffer_load_dwordx4 v229, s[12:15], s66 offen lds
    s_min_u32 s56, s56, s57
    s_lshl_b32 s56, s56, 14
    s_add_u32 s56, s56, s58
    v_mfma_f32_16x16x32_bf16 v[98:101], v[70:73], v[62:65], v[98:101]
    ds_read_b64_tr_b16 v[172:173], v238 offset:62784
    ds_read_b128 v[174:177], v235 offset:16384
    s_add_u32 m0, m0, s78
    s_and_b32 s55, s55, 255
    v_xor_b32 v14, s55, v5
    v_add_u32 v14, s56, v14
    v_mfma_f32_16x16x32_bf16 v[102:105], v[74:77], v[62:65], v[102:105]
    ds_read_b64_tr_b16 v[178:179], v239 offset:61440
    ds_read_b64_tr_b16 v[180:181], v239 offset:62720
    buffer_load_dwordx4 v230, s[12:15], s66 offen lds
    s_add_u32 s55, s54, 32
    s_lshr_b32 s56, s55, 8
    s_sub_u32 s56, s56, s35
    s_setprio 1
    v_mfma_f32_16x16x32_bf16 v[94:97], v[82:85], v[78:81], v[94:97]
    ds_read_b64_tr_b16 v[182:183], v239 offset:61472
    ds_read_b64_tr_b16 v[184:185], v239 offset:62752
    s_add_u32 m0, m0, s78
    s_add_u32 s57, s56, 5
    s_min_u32 s56, s56, s57
    s_lshl_b32 s56, s56, 14
    v_mfma_f32_16x16x32_bf16 v[98:101], v[86:89], v[78:81], v[98:101]
    ds_read_b64_tr_b16 v[186:187], v239 offset:61504
    ds_read_b64_tr_b16 v[188:189], v239 offset:62784
    buffer_load_dwordx4 v231, s[12:15], s66 offen lds
    s_add_u32 s56, s56, s58
    s_and_b32 s55, s55, 255
    v_xor_b32 v16, s55, v5
    v_mfma_f32_16x16x32_bf16 v[102:105], v[90:93], v[78:81], v[102:105]
    s_add_u32 s66, s66, s67
    s_sub_u32 s64, s66, s77
    v_add_u32 v16, s56, v16
    s_add_u32 s55, s53, 128
    s_lshr_b32 s56, s55, 8
    v_mfma_f32_16x16x32_bf16 v[190:193], v[120:123], v[78:81], 0
    s_cmp_ge_u32 s66, s76
    s_cselect_b32 s66, s64, s66
    s_sub_u32 s56, s56, s35
    s_add_u32 s57, s56, 5
    s_min_u32 s56, s56, s57
    v_mfma_f32_16x16x32_bf16 v[246:249], v[78:81], v[78:81], 0
    s_lshl_b32 s56, s56, 14
    s_add_u32 s56, s56, s58
    s_and_b32 s55, s55, 255
    s_waitcnt vmcnt(4)
    s_waitcnt lgkmcnt(0)
    s_barrier
    s_setprio 3
    v_mfma_f32_16x16x32_bf16 v[94:97], v[130:133], v[126:129], v[94:97]
    ds_read_b128 v[30:33], v232 offset:32768
    ds_read_b64_tr_b16 v[34:35], v236 offset:0
    v_xor_b32 v18, s55, v5
    v_add_u32 v18, s56, v18
    s_lshl_b32 s50, s24, 15
    v_mfma_f32_16x16x32_bf16 v[106:109], v[130:133], v[120:123], v[106:109]
    ds_read_b64_tr_b16 v[36:37], v236 offset:1280
    ds_read_b64_tr_b16 v[38:39], v236 offset:32
    v_add_u32 v20, s50, v2
    v_and_b32 v5, 31, v1
    v_min_u32 v5, 20, v5
    v_mfma_f32_16x16x32_bf16 v[98:101], v[134:137], v[126:129], v[98:101]
    ds_read_b64_tr_b16 v[40:41], v236 offset:1312
    ds_read_b64_tr_b16 v[42:43], v236 offset:64
    v_lshlrev_b32 v5, 4, v5
    v_lshrrev_b32 v6, 5, v1
    v_mul_u32_u24 v8, 336, v6
    v_mfma_f32_16x16x32_bf16 v[110:113], v[134:137], v[120:123], v[110:113]
    ds_read_b64_tr_b16 v[44:45], v236 offset:1344
    ds_read_b128 v[46:49], v233 offset:32768
    s_mul_i32 s50, s24, 43008
    s_add_u32 s50, s50, 65536
    v_add3_u32 v21, v5, v8, s50
    v_mfma_f32_16x16x32_bf16 v[102:105], v[138:141], v[126:129], v[102:105]
    ds_read_b64_tr_b16 v[50:51], v237 offset:0
    ds_read_b64_tr_b16 v[52:53], v237 offset:1280
    s_mov_b32 vcc_lo, 0xffe00000
    s_mov_b32 vcc_hi, 0xffe00000
    v_mov_b32 v5, 0x40000
    v_mfma_f32_16x16x32_bf16 v[114:117], v[138:141], v[120:123], v[114:117]
    ds_read_b64_tr_b16 v[54:55], v237 offset:32
    ds_read_b64_tr_b16 v[56:57], v237 offset:1312
    v_cndmask_b32 v21, v21, v5, vcc
    s_lshl_b32 s79, s21, 2
    s_add_u32 s79, s79, s23
    s_setprio 2
    v_mfma_f32_16x16x32_bf16 v[94:97], v[146:149], v[142:145], v[94:97]
    ds_read_b64_tr_b16 v[58:59], v237 offset:64
    ds_read_b64_tr_b16 v[60:61], v237 offset:1344
    s_mov_b32 m0, s17
    s_lshr_b32 s80, s26, 4
    s_and_b32 s27, s26, 15
    s_lshl_b32 s50, s21, 2
    v_mfma_f32_16x16x32_bf16 v[98:101], v[150:153], v[142:145], v[98:101]
    ds_read_b128 v[62:65], v234 offset:32768
    ds_read_b64_tr_b16 v[66:67], v238 offset:0
    buffer_load_dwordx4 v228, s[12:15], s66 offen lds
    s_lshl_b32 s51, s24, 1
    s_add_u32 s50, s50, s51
    s_mul_i32 s50, s50, 20480
    v_mfma_f32_16x16x32_bf16 v[102:105], v[154:157], v[142:145], v[102:105]
    ds_read_b64_tr_b16 v[68:69], v238 offset:1280
    ds_read_b64_tr_b16 v[70:71], v238 offset:32
    s_add_u32 m0, m0, s78
    s_add_u32 s50, s50, 3145728
    s_lshr_b32 s51, s25, 1
    s_mul_i32 s51, s51, 1280
    v_mfma_f32_16x16x32_bf16 v[94:97], v[162:165], v[158:161], v[94:97]
    ds_read_b64_tr_b16 v[72:73], v238 offset:1312
    ds_read_b64_tr_b16 v[74:75], v238 offset:64
    buffer_load_dwordx4 v229, s[12:15], s66 offen lds
    s_add_u32 s50, s50, s51
    s_and_b32 s51, s25, 1
    s_lshl_b32 s52, s51, 9
    v_mfma_f32_16x16x32_bf16 v[98:101], v[166:169], v[158:161], v[98:101]
    ds_read_b64_tr_b16 v[76:77], v238 offset:1344
    ds_read_b128 v[78:81], v235 offset:32768
    s_add_u32 m0, m0, s78
    s_add_u32 s52, s52, s50
    s_lshl_b32 s51, s51, 3
    s_add_u32 s51, s51, s50
    v_mfma_f32_16x16x32_bf16 v[102:105], v[170:173], v[158:161], v[102:105]
    ds_read_b64_tr_b16 v[82:83], v239 offset:0
    ds_read_b64_tr_b16 v[84:85], v239 offset:1280
    buffer_load_dwordx4 v230, s[12:15], s66 offen lds
    s_add_u32 s51, s51, 1024
    v_and_b32 v5, 1, v4
    v_mul_u32_u24 v5, 20480, v5
    s_setprio 1
    v_mfma_f32_16x16x32_bf16 v[94:97], v[178:181], v[174:177], v[94:97]
    ds_read_b64_tr_b16 v[86:87], v239 offset:32
    ds_read_b64_tr_b16 v[88:89], v239 offset:1312
    s_add_u32 m0, m0, s78
    v_lshl_add_u32 v5, v3, 4, v5
    v_add_u32 v25, s51, v5
    v_lshl_add_u32 v5, v6, 8, v5
    v_mfma_f32_16x16x32_bf16 v[98:101], v[182:185], v[174:177], v[98:101]
    ds_read_b64_tr_b16 v[90:91], v239 offset:64
    ds_read_b64_tr_b16 v[92:93], v239 offset:1344
    buffer_load_dwordx4 v231, s[12:15], s66 offen lds
    v_add_u32 v24, s52, v5
    s_mul_i32 s50, s24, 192
    s_add_u32 s50, s50, 143360
    v_mfma_f32_16x16x32_bf16 v[102:105], v[186:189], v[174:177], v[102:105]
    v_lshl_add_u32 v250, v4, 4, s50
    s_mul_i32 s51, s23, 384
    v_add_u32 v251, s51, v250
    v_mfma_f32_16x16x32_bf16 v[190:193], v[120:123], v[174:177], v[190:193]
    s_lshl_b32 s50, s23, 7
    s_add_u32 s50, s50, 144896
    v_lshl_add_u32 v252, v3, 3, s50
    v_mfma_f32_16x16x32_bf16 v[246:249], v[174:177], v[174:177], v[246:249]
    s_lshl_b32 s51, s24, 9
    v_add_u32 v253, s51, v252
    s_lshl_b32 s50, s23, 4
    s_waitcnt vmcnt(4)
    s_waitcnt lgkmcnt(0)
    s_barrier
    s_setprio 3
    v_mfma_f32_16x16x32_bf16 v[94:97], v[34:37], v[30:33], v[94:97]
    ds_read_b128 v[126:129], v232 offset:49152
    ds_read_b64_tr_b16 v[130:131], v236 offset:20480
    v_add_u32 v254, s50, v3
    v_mul_u32_u24 v254, 176, v254
    s_mul_i32 s50, s24, 96
    v_mfma_f32_16x16x32_bf16 v[106:109], v[34:37], v[120:123], v[106:109]
    ds_read_b64_tr_b16 v[132:133], v236 offset:21760
    ds_read_b64_tr_b16 v[134:135], v236 offset:20512
    s_add_u32 s50, s50, 151552
    v_lshl_add_u32 v254, v4, 3, v254
    v_add_u32 v254, s50, v254
    v_mfma_f32_16x16x32_bf16 v[98:101], v[38:41], v[30:33], v[98:101]
    ds_read_b64_tr_b16 v[136:137], v236 offset:21792
    ds_read_b64_tr_b16 v[138:139], v236 offset:20544
    s_mul_i32 s50, s23, 40
    s_add_u32 s50, s50, 151552
    v_and_b32 v255, 31, v1
    v_mfma_f32_16x16x32_bf16 v[110:113], v[38:41], v[120:123], v[110:113]
    ds_read_b64_tr_b16 v[140:141], v236 offset:21824
    ds_read_b128 v[142:145], v233 offset:49152
    v_mul_u32_u24 v255, 176, v255
    v_lshrrev_b32 v200, 5, v1
    v_lshl_add_u32 v255, v200, 4, v255
    v_mfma_f32_16x16x32_bf16 v[102:105], v[42:45], v[30:33], v[102:105]
    ds_read_b64_tr_b16 v[146:147], v237 offset:20480
    ds_read_b64_tr_b16 v[148:149], v237 offset:21760
    v_add_u32 v255, s50, v255
    v_mul_u32_u24 v200, 176, v1
    v_add_u32 v200, s50, v200
    v_mfma_f32_16x16x32_bf16 v[114:117], v[42:45], v[120:123], v[114:117]
    ds_read_b64_tr_b16 v[150:151], v237 offset:20512
    ds_read_b64_tr_b16 v[152:153], v237 offset:21792
    s_lshl_b32 s50, s23, 10
    s_add_u32 s28, s30, s50
    s_add_u32 s29, s28, s50
    s_setprio 2
    v_mfma_f32_16x16x32_bf16 v[94:97], v[50:53], v[46:49], v[94:97]
    ds_read_b64_tr_b16 v[154:155], v237 offset:20544
    ds_read_b64_tr_b16 v[156:157], v237 offset:21824
    s_add_u32 s53, s29, s50
    s_add_u32 s54, s31, s50
    s_add_u32 s55, s54, s50
    v_mfma_f32_16x16x32_bf16 v[98:101], v[54:57], v[46:49], v[98:101]
    ds_read_b128 v[158:161], v234 offset:49152
    ds_read_b64_tr_b16 v[162:163], v238 offset:20480
    s_add_u32 s56, s55, s50
    s_mul_i32 s50, s22, 102400
    s_add_u32 s50, s50, 15728640
    v_mfma_f32_16x16x32_bf16 v[102:105], v[58:61], v[46:49], v[102:105]
    ds_read_b64_tr_b16 v[164:165], v238 offset:21760
    ds_read_b64_tr_b16 v[166:167], v238 offset:20512
    s_mul_i32 s51, s24, 18432
    s_add_u32 s57, s50, s51
    s_mul_i32 s51, s24, 8192
    v_mfma_f32_16x16x32_bf16 v[94:97], v[66:69], v[62:65], v[94:97]
    ds_read_b64_tr_b16 v[168:169], v238 offset:21792
    ds_read_b64_tr_b16 v[170:171], v238 offset:20544
    s_add_u32 s58, s50, s51
    s_sub_u32 s58, s58, 45056
    s_mul_i32 s51, s24, 45056
    v_mfma_f32_16x16x32_bf16 v[98:101], v[70:73], v[62:65], v[98:101]
    ds_read_b64_tr_b16 v[172:173], v238 offset:21824
    ds_read_b128 v[174:177], v235 offset:49152
    s_add_u32 s60, s50, s51
    s_sub_u32 s60, s60, 106496
    s_min_u32 s50, s23, 2
    v_mfma_f32_16x16x32_bf16 v[102:105], v[74:77], v[62:65], v[102:105]
    ds_read_b64_tr_b16 v[178:179], v239 offset:20480
    ds_read_b64_tr_b16 v[180:181], v239 offset:21760
    s_lshl_b32 s50, s50, 11
    s_mul_i32 s51, s24, 6144
    s_add_u32 s59, s50, s51
    s_setprio 1
    v_mfma_f32_16x16x32_bf16 v[94:97], v[82:85], v[78:81], v[94:97]
    ds_read_b64_tr_b16 v[182:183], v239 offset:20512
    ds_read_b64_tr_b16 v[184:185], v239 offset:21792
    s_and_b32 s50, s26, 31
    s_lshl_b32 s50, s50, 3
    s_add_u32 s50, s50, s20
    v_mfma_f32_16x16x32_bf16 v[98:101], v[86:89], v[78:81], v[98:101]
    ds_read_b64_tr_b16 v[186:187], v239 offset:20544
    ds_read_b64_tr_b16 v[188:189], v239 offset:21824
    s_lshl_b32 s61, s50, 11
    s_and_b32 s50, s21, 3
    s_lshl_b32 s50, s50, 3
    v_mfma_f32_16x16x32_bf16 v[102:105], v[90:93], v[78:81], v[102:105]
    s_add_u32 s50, s50, s20
    s_lshl_b32 s50, s50, 11
    s_mul_i32 s62, s22, 276480
    v_mfma_f32_16x16x32_bf16 v[190:193], v[120:123], v[78:81], v[190:193]
    s_add_u32 s62, s62, s50
    v_mfma_f32_16x16x32_bf16 v[246:249], v[78:81], v[78:81], v[246:249]
    v_add_u32 v232, 65536, v232
    v_add_u32 v233, 65536, v233
    v_add_u32 v234, 65536, v234
    v_add_u32 v235, 65536, v235
    s_waitcnt vmcnt(0)
    s_waitcnt lgkmcnt(0)
    s_barrier
    ds_read_b64 v[14:15], v14
    ds_read_b64 v[16:17], v16
    ds_read_b64 v[18:19], v18
    s_setprio 3
    v_mfma_f32_16x16x32_bf16 v[94:97], v[130:133], v[126:129], v[94:97]
    ds_read_b128 v[30:33], v232 offset:0
    ds_read_b64_tr_b16 v[34:35], v236 offset:40960
    v_mfma_f32_16x16x32_bf16 v[106:109], v[130:133], v[120:123], v[106:109]
    ds_read_b64_tr_b16 v[36:37], v236 offset:42240
    ds_read_b64_tr_b16 v[38:39], v236 offset:40992
    v_mfma_f32_16x16x32_bf16 v[98:101], v[134:137], v[126:129], v[98:101]
    ds_read_b64_tr_b16 v[40:41], v236 offset:42272
    ds_read_b64_tr_b16 v[42:43], v236 offset:41024
    v_mfma_f32_16x16x32_bf16 v[110:113], v[134:137], v[120:123], v[110:113]
    ds_read_b64_tr_b16 v[44:45], v236 offset:42304
    ds_read_b128 v[46:49], v233 offset:0
    v_mfma_f32_16x16x32_bf16 v[102:105], v[138:141], v[126:129], v[102:105]
    ds_read_b64_tr_b16 v[50:51], v237 offset:40960
    ds_read_b64_tr_b16 v[52:53], v237 offset:42240
    v_mfma_f32_16x16x32_bf16 v[114:117], v[138:141], v[120:123], v[114:117]
    ds_read_b64_tr_b16 v[54:55], v237 offset:40992
    ds_read_b64_tr_b16 v[56:57], v237 offset:42272
    s_setprio 2
    v_mfma_f32_16x16x32_bf16 v[94:97], v[146:149], v[142:145], v[94:97]
    ds_read_b64_tr_b16 v[58:59], v237 offset:41024
    ds_read_b64_tr_b16 v[60:61], v237 offset:42304
    v_mfma_f32_16x16x32_bf16 v[98:101], v[150:153], v[142:145], v[98:101]
    ds_read_b128 v[62:65], v234 offset:0
    ds_read_b64_tr_b16 v[66:67], v238 offset:40960
    v_mfma_f32_16x16x32_bf16 v[102:105], v[154:157], v[142:145], v[102:105]
    ds_read_b64_tr_b16 v[68:69], v238 offset:42240
    ds_read_b64_tr_b16 v[70:71], v238 offset:40992
    v_mfma_f32_16x16x32_bf16 v[94:97], v[162:165], v[158:161], v[94:97]
    ds_read_b64_tr_b16 v[72:73], v238 offset:42272
    ds_read_b64_tr_b16 v[74:75], v238 offset:41024
    v_mfma_f32_16x16x32_bf16 v[98:101], v[166:169], v[158:161], v[98:101]
    ds_read_b64_tr_b16 v[76:77], v238 offset:42304
    ds_read_b128 v[78:81], v235 offset:0
    v_mfma_f32_16x16x32_bf16 v[102:105], v[170:173], v[158:161], v[102:105]
    ds_read_b64_tr_b16 v[82:83], v239 offset:40960
    ds_read_b64_tr_b16 v[84:85], v239 offset:42240
    s_setprio 1
    v_mfma_f32_16x16x32_bf16 v[94:97], v[178:181], v[174:177], v[94:97]
    ds_read_b64_tr_b16 v[86:87], v239 offset:40992
    ds_read_b64_tr_b16 v[88:89], v239 offset:42272
    v_mfma_f32_16x16x32_bf16 v[98:101], v[182:185], v[174:177], v[98:101]
    ds_read_b64_tr_b16 v[90:91], v239 offset:41024
    ds_read_b64_tr_b16 v[92:93], v239 offset:42304
    v_mfma_f32_16x16x32_bf16 v[102:105], v[186:189], v[174:177], v[102:105]
    v_mfma_f32_16x16x32_bf16 v[190:193], v[120:123], v[174:177], v[190:193]
    v_mfma_f32_16x16x32_bf16 v[246:249], v[174:177], v[174:177], v[246:249]
    s_mov_b32 s50, 22553600
    buffer_load_dwordx4 v[196:199], v2, s[4:7], s50 offen sc1
    s_waitcnt lgkmcnt(15)
    v_mfma_f32_16x16x32_bf16 v[106:109], v[34:37], v[120:123], v[106:109]
    v_mfma_f32_16x16x32_bf16 v[110:113], v[38:41], v[120:123], v[110:113]
    v_mfma_f32_16x16x32_bf16 v[114:117], v[42:45], v[120:123], v[114:117]
    s_waitcnt lgkmcnt(0)
    v_mfma_f32_16x16x32_bf16 v[190:193], v[120:123], v[78:81], v[190:193]
    v_mfma_f32_16x16x32_bf16 v[246:249], v[78:81], v[78:81], v[246:249]
    s_setprio 0
    s_nop 1
    ds_write_b128 v251, v[106:109] offset:0
    ds_write_b128 v251, v[110:113] offset:64
    ds_write_b128 v251, v[114:117] offset:128
    s_nop 0
    v_mov_b32 v118, v190
    s_mov_b32 vcc_lo, 0x22222222
    s_mov_b32 vcc_hi, 0x22222222
    v_cndmask_b32 v119, v246, v247, vcc
    s_mov_b32 vcc_lo, 0x44444444
    s_mov_b32 vcc_hi, 0x44444444
    v_cndmask_b32 v119, v119, v248, vcc
    s_mov_b32 vcc_lo, 0x88888888
    s_mov_b32 vcc_hi, 0x88888888
    v_cndmask_b32 v119, v119, v249, vcc
    s_mov_b32 exec_lo, 0x00f0000f
    s_mov_b32 exec_hi, 0xf0000f00
    ds_write_b64 v253, v[118:119] offset:0
    s_mov_b64 exec, -1
    s_waitcnt lgkmcnt(0)
    s_barrier
    s_setprio 2
    ds_read_b64 v[176:177], v252 offset:0
    ds_read_b64 v[178:179], v252 offset:512
    v_mfma_f32_16x16x32_bf16 v[94:97], v[34:37], v[30:33], v[94:97]
    ds_read_b128 v[126:129], v250 offset:0
    v_mfma_f32_16x16x32_bf16 v[98:101], v[38:41], v[30:33], v[98:101]
    ds_read_b128 v[130:133], v250 offset:384
    v_mfma_f32_16x16x32_bf16 v[102:105], v[42:45], v[30:33], v[102:105]
    ds_read_b128 v[134:137], v250 offset:768
    v_mfma_f32_16x16x32_bf16 v[94:97], v[50:53], v[46:49], v[94:97]
    ds_read_b128 v[138:141], v250 offset:1152
    v_mfma_f32_16x16x32_bf16 v[98:101], v[54:57], v[46:49], v[98:101]
    ds_read_b128 v[142:145], v250 offset:64
    v_mfma_f32_16x16x32_bf16 v[102:105], v[58:61], v[46:49], v[102:105]
    ds_read_b128 v[146:149], v250 offset:448
    v_mfma_f32_16x16x32_bf16 v[94:97], v[66:69], v[62:65], v[94:97]
    ds_read_b128 v[150:153], v250 offset:832
    v_mfma_f32_16x16x32_bf16 v[98:101], v[70:73], v[62:65], v[98:101]
    ds_read_b128 v[154:157], v250 offset:1216
    v_mfma_f32_16x16x32_bf16 v[102:105], v[74:77], v[62:65], v[102:105]
    ds_read_b128 v[158:161], v250 offset:128
    v_mfma_f32_16x16x32_bf16 v[94:97], v[82:85], v[78:81], v[94:97]
    ds_read_b128 v[162:165], v250 offset:512
    v_mfma_f32_16x16x32_bf16 v[98:101], v[86:89], v[78:81], v[98:101]
    ds_read_b128 v[166:169], v250 offset:896
    v_mfma_f32_16x16x32_bf16 v[102:105], v[90:93], v[78:81], v[102:105]
    ds_read_b128 v[170:173], v250 offset:1280
    s_setprio 1
    s_waitcnt vmcnt(0)
    v_xor_b32 v196, s34, v196
    v_xor_b32 v197, s34, v197
    v_xor_b32 v198, s34, v198
    v_xor_b32 v199, s34, v199
    v_or3_b32 v196, v196, v197, v198
    v_or_b32 v196, v196, v199
    v_cmp_lt_u32 vcc, 7, v196
    s_mov_b64 s[76:77], vcc
    s_cmp_lg_u64 s[76:77], 0
    s_cbranch_scc1 L_sequ_kv1_22
    s_add_u32 m0, s30, 0
    s_add_u32 s65, m0, 2621440
    buffer_load_dwordx4 v2, s[4:7], s65 offen sc1 lds
    s_add_u32 m0, s32, 16384
    s_nop 0
    buffer_load_dwordx4 v2, s[4:7], s33 offen offset:0 sc1 lds
    buffer_load_dwordx4 v2, s[4:7], s33 offen offset:1024 sc1 lds
    s_add_u32 m0, s31, 0
    s_add_u32 s65, m0, 2621440
    buffer_load_dwordx4 v2, s[4:7], s65 offen sc1 lds
L_sequ_kv1_22:
    s_waitcnt lgkmcnt(12)
    v_add_f32 v176, v176, v178
    v_add_f32 v177, v177, v179
    v_mul_f32 v180, 0x3acccccd, v176
    v_mul_f32 v177, 0x3acccccd, v177
    v_fma_f32 v177, -v180, v180, v177
    v_max_f32 v177, 0, v177
    v_cvt_pk_bf16_f32 v177, v180, v177
    v_lshlrev_b32 v180, 16, v177
    v_and_b32 v177, 0xffff0000, v177
    v_add_f32 v177, 0x3727c5ac, v177
    v_cvt_pk_bf16_f32 v177, 0, v177
    v_sqrt_f32 v177, v177
    v_mov_b32 v181, v180
    v_cvt_pk_bf16_f32 v177, 0, v177
    v_rcp_f32 v182, v177
    s_nop 0
    v_mul_f32 v182, 0x3ea52b5c, v182
    v_mov_b32 v183, v182
    s_setprio 0
    s_waitcnt lgkmcnt(0)
    v_pk_add_f32 v[126:127], v[126:127], v[130:131]
    v_pk_add_f32 v[128:129], v[128:129], v[132:133]
    v_pk_add_f32 v[142:143], v[142:143], v[146:147]
    v_pk_add_f32 v[144:145], v[144:145], v[148:149]
    v_pk_add_f32 v[158:159], v[158:159], v[162:163]
    v_pk_add_f32 v[160:161], v[160:161], v[164:165]
    v_pk_add_f32 v[134:135], v[134:135], v[138:139]
    v_pk_add_f32 v[136:137], v[136:137], v[140:141]
    v_pk_add_f32 v[150:151], v[150:151], v[154:155]
    v_pk_add_f32 v[152:153], v[152:153], v[156:157]
    v_pk_add_f32 v[166:167], v[166:167], v[170:171]
    v_pk_add_f32 v[168:169], v[168:169], v[172:173]
    v_pk_add_f32 v[126:127], v[126:127], v[134:135]
    v_pk_add_f32 v[128:129], v[128:129], v[136:137]
    v_pk_add_f32 v[142:143], v[142:143], v[150:151]
    v_pk_add_f32 v[144:145], v[144:145], v[152:153]
    v_pk_add_f32 v[158:159], v[158:159], v[166:167]
    v_pk_add_f32 v[160:161], v[160:161], v[168:169]
    v_pk_fma_f32 v[94:95], v[180:181], v[126:127], v[94:95] neg_lo:[1,0,0] neg_hi:[1,0,0]
    v_pk_fma_f32 v[96:97], v[180:181], v[128:129], v[96:97] neg_lo:[1,0,0] neg_hi:[1,0,0]
    v_pk_fma_f32 v[98:99], v[180:181], v[142:143], v[98:99] neg_lo:[1,0,0] neg_hi:[1,0,0]
    v_pk_fma_f32 v[100:101], v[180:181], v[144:145], v[100:101] neg_lo:[1,0,0] neg_hi:[1,0,0]
    v_pk_fma_f32 v[102:103], v[180:181], v[158:159], v[102:103] neg_lo:[1,0,0] neg_hi:[1,0,0]
    v_pk_fma_f32 v[104:105], v[180:181], v[160:161], v[104:105] neg_lo:[1,0,0] neg_hi:[1,0,0]
    v_pk_mul_f32 v[94:95], v[94:95], v[182:183]
    v_pk_mul_f32 v[96:97], v[96:97], v[182:183]
    v_pk_mul_f32 v[98:99], v[98:99], v[182:183]
    v_pk_mul_f32 v[100:101], v[100:101], v[182:183]
    v_pk_mul_f32 v[102:103], v[102:103], v[182:183]
    v_pk_mul_f32 v[104:105], v[104:105], v[182:183]
    v_cvt_pk_bf16_f32 v184, v94, v95
    v_cvt_pk_bf16_f32 v185, v96, v97
    ds_write_b64 v254, v[184:185] offset:0
    v_cvt_pk_bf16_f32 v186, v98, v99
    v_cvt_pk_bf16_f32 v187, v100, v101
    ds_write_b64 v254, v[186:187] offset:32
    v_cvt_pk_bf16_f32 v188, v102, v103
    v_cvt_pk_bf16_f32 v189, v104, v105
    ds_write_b64 v254, v[188:189] offset:64
    s_branch L_sequ_q3_19
L_sequ_qf1_18:
    ds_read_b128 v[30:33], v232 offset:0
    ds_read_b64_tr_b16 v[34:35], v236 offset:40960
    ds_read_b64_tr_b16 v[36:37], v236 offset:42240
    ds_read_b64_tr_b16 v[38:39], v236 offset:40992
    ds_read_b64_tr_b16 v[40:41], v236 offset:42272
    ds_read_b128 v[46:49], v233 offset:0
    ds_read_b64_tr_b16 v[50:51], v237 offset:40960
    ds_read_b64_tr_b16 v[52:53], v237 offset:42240
    ds_read_b64_tr_b16 v[54:55], v237 offset:40992
    ds_read_b64_tr_b16 v[56:57], v237 offset:42272
    ds_read_b128 v[62:65], v234 offset:0
    ds_read_b64_tr_b16 v[66:67], v238 offset:40960
    ds_read_b64_tr_b16 v[68:69], v238 offset:42240
    ds_read_b64_tr_b16 v[70:71], v238 offset:40992
    ds_read_b64_tr_b16 v[72:73], v238 offset:42272
    ds_read_b128 v[78:81], v235 offset:0
    ds_read_b64_tr_b16 v[82:83], v239 offset:40960
    ds_read_b64_tr_b16 v[84:85], v239 offset:42240
    ds_read_b64_tr_b16 v[86:87], v239 offset:40992
    ds_read_b64_tr_b16 v[88:89], v239 offset:42272
    s_cmp_eq_u32 s20, 7
    s_cbranch_scc1 L_sequ_w7s_23
    s_waitcnt vmcnt(0)
L_sequ_w7s_23:
    s_cmp_lt_u32 s20, 5
    s_cbranch_scc1 L_sequ_bw_24
    s_add_u32 m0, s63, 32768
    s_nop 0
    buffer_load_dwordx4 v228, s[12:15], s66 offen lds
    s_add_u32 m0, s63, 33792
    s_nop 0
    buffer_load_dwordx4 v229, s[12:15], s66 offen lds
    s_add_u32 m0, s63, 34816
    s_nop 0
    buffer_load_dwordx4 v230, s[12:15], s66 offen lds
    s_add_u32 m0, s63, 35840
    s_nop 0
    buffer_load_dwordx4 v231, s[12:15], s66 offen lds
    s_branch L_sequ_bj_25
L_sequ_bw_24:
    s_add_u32 m0, s63, 0
    s_nop 0
    buffer_load_dwordx4 v228, s[12:15], s66 offen lds
    s_add_u32 m0, s63, 5120
    s_nop 0
    buffer_load_dwordx4 v229, s[12:15], s66 offen lds
    s_add_u32 m0, s63, 10240
    s_nop 0
    buffer_load_dwordx4 v230, s[12:15], s66 offen lds
    s_add_u32 m0, s63, 15360
    s_nop 0
    buffer_load_dwordx4 v231, s[12:15], s66 offen lds
L_sequ_bj_25:
    s_add_u32 s66, s66, s67
    s_sub_u32 s64, s66, s77
    s_cmp_ge_u32 s66, s76
    s_cselect_b32 s66, s64, s66
    s_waitcnt lgkmcnt(0)
    s_barrier
    s_setprio 3
    v_mfma_f32_16x16x32_bf16 v[94:97], v[34:37], v[30:33], 0
    ds_read_b128 v[126:129], v232 offset:16384
    ds_read_b64_tr_b16 v[130:131], v236 offset:61440
    v_mfma_f32_16x16x32_bf16 v[106:109], v[34:37], v[120:123], 0
    ds_read_b64_tr_b16 v[132:133], v236 offset:62720
    ds_read_b64_tr_b16 v[134:135], v236 offset:61472
    v_mfma_f32_16x16x32_bf16 v[98:101], v[38:41], v[30:33], 0
    ds_read_b64_tr_b16 v[136:137], v236 offset:62752
    ds_read_b128 v[142:145], v233 offset:16384
    v_mfma_f32_16x16x32_bf16 v[110:113], v[38:41], v[120:123], 0
    ds_read_b64_tr_b16 v[146:147], v237 offset:61440
    ds_read_b64_tr_b16 v[148:149], v237 offset:62720
    v_mfma_f32_16x16x32_bf16 v[190:193], v[120:123], v[30:33], 0
    ds_read_b64_tr_b16 v[150:151], v237 offset:61472
    ds_read_b64_tr_b16 v[152:153], v237 offset:62752
    v_mfma_f32_16x16x32_bf16 v[246:249], v[30:33], v[30:33], 0
    ds_read_b128 v[158:161], v234 offset:16384
    ds_read_b64_tr_b16 v[162:163], v238 offset:61440
    s_setprio 2
    v_mfma_f32_16x16x32_bf16 v[94:97], v[50:53], v[46:49], v[94:97]
    ds_read_b64_tr_b16 v[164:165], v238 offset:62720
    ds_read_b64_tr_b16 v[166:167], v238 offset:61472
    s_cmp_lg_u32 s20, 7
    s_cbranch_scc1 L_sequ_w7_26
    s_lshl_b32 s50, s26, 2
    s_add_u32 s50, s50, 22553600
    s_waitcnt vmcnt(0)
    v_mov_b32 v11, 0
    v_mov_b32 v12, s34
    s_mov_b64 exec, 1
    buffer_store_dword v12, v11, s[4:7], s50 offen sc1
    s_mov_b64 exec, -1
L_sequ_w7_26:
    v_mfma_f32_16x16x32_bf16 v[98:101], v[54:57], v[46:49], v[98:101]
    ds_read_b64_tr_b16 v[168:169], v238 offset:62752
    ds_read_b128 v[174:177], v235 offset:16384
    s_mov_b32 m0, s16
    v_mfma_f32_16x16x32_bf16 v[190:193], v[120:123], v[46:49], v[190:193]
    ds_read_b64_tr_b16 v[178:179], v239 offset:61440
    ds_read_b64_tr_b16 v[180:181], v239 offset:62720
    buffer_load_dwordx4 v228, s[12:15], s66 offen lds
    v_mfma_f32_16x16x32_bf16 v[246:249], v[46:49], v[46:49], v[246:249]
    ds_read_b64_tr_b16 v[182:183], v239 offset:61472
    ds_read_b64_tr_b16 v[184:185], v239 offset:62752
    s_add_u32 m0, m0, s78
    v_mfma_f32_16x16x32_bf16 v[94:97], v[66:69], v[62:65], v[94:97]
    buffer_load_dwordx4 v229, s[12:15], s66 offen lds
    s_setprio 1
    v_mfma_f32_16x16x32_bf16 v[98:101], v[70:73], v[62:65], v[98:101]
    s_add_u32 m0, m0, s78
    v_mfma_f32_16x16x32_bf16 v[190:193], v[120:123], v[62:65], v[190:193]
    buffer_load_dwordx4 v230, s[12:15], s66 offen lds
    v_mfma_f32_16x16x32_bf16 v[246:249], v[62:65], v[62:65], v[246:249]
    s_add_u32 m0, m0, s78
    v_mfma_f32_16x16x32_bf16 v[94:97], v[82:85], v[78:81], v[94:97]
    buffer_load_dwordx4 v231, s[12:15], s66 offen lds
    v_mfma_f32_16x16x32_bf16 v[98:101], v[86:89], v[78:81], v[98:101]
    s_add_u32 s66, s66, s67
    s_sub_u32 s64, s66, s77
    s_cmp_ge_u32 s66, s76
    s_cselect_b32 s66, s64, s66
    s_cmp_eq_u32 s20, 7
    s_cbranch_scc1 L_sequ_w7t_27
    s_waitcnt vmcnt(4)
L_sequ_w7t_27:
    s_waitcnt lgkmcnt(0)
    s_barrier
    s_setprio 3
    v_mfma_f32_16x16x32_bf16 v[94:97], v[130:133], v[126:129], v[94:97]
    ds_read_b128 v[30:33], v232 offset:32768
    ds_read_b64_tr_b16 v[34:35], v236 offset:0
    v_mfma_f32_16x16x32_bf16 v[106:109], v[130:133], v[120:123], v[106:109]
    ds_read_b64_tr_b16 v[36:37], v236 offset:1280
    ds_read_b64_tr_b16 v[38:39], v236 offset:32
    v_mfma_f32_16x16x32_bf16 v[98:101], v[134:137], v[126:129], v[98:101]
    ds_read_b64_tr_b16 v[40:41], v236 offset:1312
    ds_read_b128 v[46:49], v233 offset:32768
    v_mfma_f32_16x16x32_bf16 v[110:113], v[134:137], v[120:123], v[110:113]
    ds_read_b64_tr_b16 v[50:51], v237 offset:0
    ds_read_b64_tr_b16 v[52:53], v237 offset:1280
    v_mfma_f32_16x16x32_bf16 v[190:193], v[120:123], v[126:129], v[190:193]
    ds_read_b64_tr_b16 v[54:55], v237 offset:32
    ds_read_b64_tr_b16 v[56:57], v237 offset:1312
    v_mfma_f32_16x16x32_bf16 v[246:249], v[126:129], v[126:129], v[246:249]
    ds_read_b128 v[62:65], v234 offset:32768
    ds_read_b64_tr_b16 v[66:67], v238 offset:0
    s_setprio 2
    v_mfma_f32_16x16x32_bf16 v[94:97], v[146:149], v[142:145], v[94:97]
    ds_read_b64_tr_b16 v[68:69], v238 offset:1280
    ds_read_b64_tr_b16 v[70:71], v238 offset:32
    s_mov_b32 m0, s17
    v_mfma_f32_16x16x32_bf16 v[98:101], v[150:153], v[142:145], v[98:101]
    ds_read_b64_tr_b16 v[72:73], v238 offset:1312
    ds_read_b128 v[78:81], v235 offset:32768
    buffer_load_dwordx4 v228, s[12:15], s66 offen lds
    v_mfma_f32_16x16x32_bf16 v[190:193], v[120:123], v[142:145], v[190:193]
    ds_read_b64_tr_b16 v[82:83], v239 offset:0
    ds_read_b64_tr_b16 v[84:85], v239 offset:1280
    s_add_u32 m0, m0, s78
    v_mfma_f32_16x16x32_bf16 v[246:249], v[142:145], v[142:145], v[246:249]
    ds_read_b64_tr_b16 v[86:87], v239 offset:32
    ds_read_b64_tr_b16 v[88:89], v239 offset:1312
    buffer_load_dwordx4 v229, s[12:15], s66 offen lds
    v_mfma_f32_16x16x32_bf16 v[94:97], v[162:165], v[158:161], v[94:97]
    s_add_u32 m0, m0, s78
    s_setprio 1
    v_mfma_f32_16x16x32_bf16 v[98:101], v[166:169], v[158:161], v[98:101]
    buffer_load_dwordx4 v230, s[12:15], s66 offen lds
    v_mfma_f32_16x16x32_bf16 v[190:193], v[120:123], v[158:161], v[190:193]
    s_add_u32 m0, m0, s78
    v_mfma_f32_16x16x32_bf16 v[246:249], v[158:161], v[158:161], v[246:249]
    buffer_load_dwordx4 v231, s[12:15], s66 offen lds
    v_mfma_f32_16x16x32_bf16 v[94:97], v[178:181], v[174:177], v[94:97]
    v_mfma_f32_16x16x32_bf16 v[98:101], v[182:185], v[174:177], v[98:101]
    s_waitcnt vmcnt(4)
    s_waitcnt lgkmcnt(0)
    s_barrier
    s_setprio 3
    v_mfma_f32_16x16x32_bf16 v[94:97], v[34:37], v[30:33], v[94:97]
    ds_read_b128 v[126:129], v232 offset:49152
    ds_read_b64_tr_b16 v[130:131], v236 offset:20480
    v_mfma_f32_16x16x32_bf16 v[106:109], v[34:37], v[120:123], v[106:109]
    ds_read_b64_tr_b16 v[132:133], v236 offset:21760
    ds_read_b64_tr_b16 v[134:135], v236 offset:20512
    v_mfma_f32_16x16x32_bf16 v[98:101], v[38:41], v[30:33], v[98:101]
    ds_read_b64_tr_b16 v[136:137], v236 offset:21792
    ds_read_b128 v[142:145], v233 offset:49152
    v_mfma_f32_16x16x32_bf16 v[110:113], v[38:41], v[120:123], v[110:113]
    ds_read_b64_tr_b16 v[146:147], v237 offset:20480
    ds_read_b64_tr_b16 v[148:149], v237 offset:21760
    v_mfma_f32_16x16x32_bf16 v[190:193], v[120:123], v[30:33], v[190:193]
    ds_read_b64_tr_b16 v[150:151], v237 offset:20512
    ds_read_b64_tr_b16 v[152:153], v237 offset:21792
    v_mfma_f32_16x16x32_bf16 v[246:249], v[30:33], v[30:33], v[246:249]
    ds_read_b128 v[158:161], v234 offset:49152
    ds_read_b64_tr_b16 v[162:163], v238 offset:20480
    s_setprio 2
    v_mfma_f32_16x16x32_bf16 v[94:97], v[50:53], v[46:49], v[94:97]
    ds_read_b64_tr_b16 v[164:165], v238 offset:21760
    ds_read_b64_tr_b16 v[166:167], v238 offset:20512
    v_mfma_f32_16x16x32_bf16 v[98:101], v[54:57], v[46:49], v[98:101]
    ds_read_b64_tr_b16 v[168:169], v238 offset:21792
    ds_read_b128 v[174:177], v235 offset:49152
    v_mfma_f32_16x16x32_bf16 v[190:193], v[120:123], v[46:49], v[190:193]
    ds_read_b64_tr_b16 v[178:179], v239 offset:20480
    ds_read_b64_tr_b16 v[180:181], v239 offset:21760
    v_mfma_f32_16x16x32_bf16 v[246:249], v[46:49], v[46:49], v[246:249]
    ds_read_b64_tr_b16 v[182:183], v239 offset:20512
    ds_read_b64_tr_b16 v[184:185], v239 offset:21792
    v_mfma_f32_16x16x32_bf16 v[94:97], v[66:69], v[62:65], v[94:97]
    s_setprio 1
    v_mfma_f32_16x16x32_bf16 v[98:101], v[70:73], v[62:65], v[98:101]
    v_mfma_f32_16x16x32_bf16 v[190:193], v[120:123], v[62:65], v[190:193]
    v_mfma_f32_16x16x32_bf16 v[246:249], v[62:65], v[62:65], v[246:249]
    v_mfma_f32_16x16x32_bf16 v[94:97], v[82:85], v[78:81], v[94:97]
    v_mfma_f32_16x16x32_bf16 v[98:101], v[86:89], v[78:81], v[98:101]
    v_add_u32 v232, 65536, v232
    v_add_u32 v233, 65536, v233
    v_add_u32 v234, 65536, v234
    v_add_u32 v235, 65536, v235
    s_waitcnt vmcnt(0)
    s_waitcnt lgkmcnt(0)
    s_barrier
    ds_read_b64 v[14:15], v14
    ds_read_b64 v[16:17], v16
    ds_read_b64 v[18:19], v18
    s_setprio 3
    v_mfma_f32_16x16x32_bf16 v[94:97], v[130:133], v[126:129], v[94:97]
    ds_read_b128 v[30:33], v232 offset:0
    ds_read_b64_tr_b16 v[34:35], v236 offset:40960
    v_mfma_f32_16x16x32_bf16 v[106:109], v[130:133], v[120:123], v[106:109]
    ds_read_b64_tr_b16 v[36:37], v236 offset:42240
    ds_read_b64_tr_b16 v[38:39], v236 offset:40992
    v_mfma_f32_16x16x32_bf16 v[98:101], v[134:137], v[126:129], v[98:101]
    ds_read_b64_tr_b16 v[40:41], v236 offset:42272
    ds_read_b128 v[46:49], v233 offset:0
    v_mfma_f32_16x16x32_bf16 v[110:113], v[134:137], v[120:123], v[110:113]
    ds_read_b64_tr_b16 v[50:51], v237 offset:40960
    ds_read_b64_tr_b16 v[52:53], v237 offset:42240
    v_mfma_f32_16x16x32_bf16 v[190:193], v[120:123], v[126:129], v[190:193]
    ds_read_b64_tr_b16 v[54:55], v237 offset:40992
    ds_read_b64_tr_b16 v[56:57], v237 offset:42272
    v_mfma_f32_16x16x32_bf16 v[246:249], v[126:129], v[126:129], v[246:249]
    ds_read_b128 v[62:65], v234 offset:0
    ds_read_b64_tr_b16 v[66:67], v238 offset:40960
    s_setprio 2
    v_mfma_f32_16x16x32_bf16 v[94:97], v[146:149], v[142:145], v[94:97]
    ds_read_b64_tr_b16 v[68:69], v238 offset:42240
    ds_read_b64_tr_b16 v[70:71], v238 offset:40992
    v_mfma_f32_16x16x32_bf16 v[98:101], v[150:153], v[142:145], v[98:101]
    ds_read_b64_tr_b16 v[72:73], v238 offset:42272
    ds_read_b128 v[78:81], v235 offset:0
    v_mfma_f32_16x16x32_bf16 v[190:193], v[120:123], v[142:145], v[190:193]
    ds_read_b64_tr_b16 v[82:83], v239 offset:40960
    ds_read_b64_tr_b16 v[84:85], v239 offset:42240
    v_mfma_f32_16x16x32_bf16 v[246:249], v[142:145], v[142:145], v[246:249]
    ds_read_b64_tr_b16 v[86:87], v239 offset:40992
    ds_read_b64_tr_b16 v[88:89], v239 offset:42272
    v_mfma_f32_16x16x32_bf16 v[94:97], v[162:165], v[158:161], v[94:97]
    s_setprio 1
    v_mfma_f32_16x16x32_bf16 v[98:101], v[166:169], v[158:161], v[98:101]
    v_mfma_f32_16x16x32_bf16 v[190:193], v[120:123], v[158:161], v[190:193]
    v_mfma_f32_16x16x32_bf16 v[246:249], v[158:161], v[158:161], v[246:249]
    v_mfma_f32_16x16x32_bf16 v[94:97], v[178:181], v[174:177], v[94:97]
    v_mfma_f32_16x16x32_bf16 v[98:101], v[182:185], v[174:177], v[98:101]
    s_mov_b32 s50, 22553600
    buffer_load_dwordx4 v[196:199], v2, s[4:7], s50 offen sc1
    s_waitcnt lgkmcnt(15)
    v_mfma_f32_16x16x32_bf16 v[106:109], v[34:37], v[120:123], v[106:109]
    v_mfma_f32_16x16x32_bf16 v[110:113], v[38:41], v[120:123], v[110:113]
    v_mfma_f32_16x16x32_bf16 v[190:193], v[120:123], v[30:33], v[190:193]
    v_mfma_f32_16x16x32_bf16 v[246:249], v[30:33], v[30:33], v[246:249]
    s_waitcnt lgkmcnt(10)
    v_mfma_f32_16x16x32_bf16 v[190:193], v[120:123], v[46:49], v[190:193]
    v_mfma_f32_16x16x32_bf16 v[246:249], v[46:49], v[46:49], v[246:249]
    s_waitcnt lgkmcnt(5)
    v_mfma_f32_16x16x32_bf16 v[190:193], v[120:123], v[62:65], v[190:193]
    v_mfma_f32_16x16x32_bf16 v[246:249], v[62:65], v[62:65], v[246:249]
    s_setprio 0
    ds_write_b128 v251, v[106:109] offset:0
    ds_write_b128 v251, v[110:113] offset:64
    s_nop 3
    v_mov_b32 v118, v190
    s_mov_b32 vcc_lo, 0x22222222
    s_mov_b32 vcc_hi, 0x22222222
    v_cndmask_b32 v119, v246, v247, vcc
    s_mov_b32 vcc_lo, 0x44444444
    s_mov_b32 vcc_hi, 0x44444444
    v_cndmask_b32 v119, v119, v248, vcc
    s_mov_b32 vcc_lo, 0x88888888
    s_mov_b32 vcc_hi, 0x88888888
    v_cndmask_b32 v119, v119, v249, vcc
    s_mov_b32 exec_lo, 0x00f0000f
    s_mov_b32 exec_hi, 0xf0000f00
    ds_write_b64 v253, v[118:119] offset:0
    s_mov_b64 exec, -1
    s_waitcnt lgkmcnt(0)
    s_barrier
    s_setprio 2
    ds_read_b64 v[176:177], v252 offset:0
    ds_read_b64 v[178:179], v252 offset:512
    v_mfma_f32_16x16x32_bf16 v[94:97], v[34:37], v[30:33], v[94:97]
    ds_read_b128 v[126:129], v250 offset:0
    v_mfma_f32_16x16x32_bf16 v[98:101], v[38:41], v[30:33], v[98:101]
    ds_read_b128 v[130:133], v250 offset:384
    v_mfma_f32_16x16x32_bf16 v[94:97], v[50:53], v[46:49], v[94:97]
    ds_read_b128 v[134:137], v250 offset:768
    v_mfma_f32_16x16x32_bf16 v[98:101], v[54:57], v[46:49], v[98:101]
    ds_read_b128 v[138:141], v250 offset:1152
    v_mfma_f32_16x16x32_bf16 v[94:97], v[66:69], v[62:65], v[94:97]
    ds_read_b128 v[142:145], v250 offset:64
    v_mfma_f32_16x16x32_bf16 v[98:101], v[70:73], v[62:65], v[98:101]
    ds_read_b128 v[146:149], v250 offset:448
    v_mfma_f32_16x16x32_bf16 v[94:97], v[82:85], v[78:81], v[94:97]
    ds_read_b128 v[150:153], v250 offset:832
    v_mfma_f32_16x16x32_bf16 v[98:101], v[86:89], v[78:81], v[98:101]
    ds_read_b128 v[154:157], v250 offset:1216
    s_setprio 1
    s_waitcnt vmcnt(0)
    v_xor_b32 v196, s34, v196
    v_xor_b32 v197, s34, v197
    v_xor_b32 v198, s34, v198
    v_xor_b32 v199, s34, v199
    v_or3_b32 v196, v196, v197, v198
    v_or_b32 v196, v196, v199
    v_cmp_lt_u32 vcc, 7, v196
    s_mov_b64 s[76:77], vcc
    s_cmp_lg_u64 s[76:77], 0
    s_cbranch_scc1 L_sequ_kv1_28
    s_add_u32 m0, s30, 0
    s_add_u32 s65, m0, 2621440
    buffer_load_dwordx4 v2, s[4:7], s65 offen sc1 lds
    s_add_u32 m0, s32, 16384
    s_nop 0
    buffer_load_dwordx4 v2, s[4:7], s33 offen offset:0 sc1 lds
    buffer_load_dwordx4 v2, s[4:7], s33 offen offset:1024 sc1 lds
    s_add_u32 m0, s31, 0
    s_add_u32 s65, m0, 2621440
    buffer_load_dwordx4 v2, s[4:7], s65 offen sc1 lds
L_sequ_kv1_28:
    s_waitcnt lgkmcnt(8)
    v_add_f32 v176, v176, v178
    v_add_f32 v177, v177, v179
    v_mul_f32 v180, 0x3acccccd, v176
    v_mul_f32 v177, 0x3acccccd, v177
    v_fma_f32 v177, -v180, v180, v177
    v_max_f32 v177, 0, v177
    v_cvt_pk_bf16_f32 v177, v180, v177
    v_lshlrev_b32 v180, 16, v177
    v_and_b32 v177, 0xffff0000, v177
    v_add_f32 v177, 0x3727c5ac, v177
    v_cvt_pk_bf16_f32 v177, 0, v177
    v_sqrt_f32 v177, v177
    v_mov_b32 v181, v180
    v_cvt_pk_bf16_f32 v177, 0, v177
    v_rcp_f32 v182, v177
    s_nop 0
    v_mul_f32 v182, 0x3ea52b5c, v182
    v_mov_b32 v183, v182
    s_setprio 0
    s_waitcnt lgkmcnt(0)
    v_pk_add_f32 v[126:127], v[126:127], v[130:131]
    v_pk_add_f32 v[128:129], v[128:129], v[132:133]
    v_pk_add_f32 v[142:143], v[142:143], v[146:147]
    v_pk_add_f32 v[144:145], v[144:145], v[148:149]
    v_pk_add_f32 v[134:135], v[134:135], v[138:139]
    v_pk_add_f32 v[136:137], v[136:137], v[140:141]
    v_pk_add_f32 v[150:151], v[150:151], v[154:155]
    v_pk_add_f32 v[152:153], v[152:153], v[156:157]
    v_pk_add_f32 v[126:127], v[126:127], v[134:135]
    v_pk_add_f32 v[128:129], v[128:129], v[136:137]
    v_pk_add_f32 v[142:143], v[142:143], v[150:151]
    v_pk_add_f32 v[144:145], v[144:145], v[152:153]
    v_pk_fma_f32 v[94:95], v[180:181], v[126:127], v[94:95] neg_lo:[1,0,0] neg_hi:[1,0,0]
    v_pk_fma_f32 v[96:97], v[180:181], v[128:129], v[96:97] neg_lo:[1,0,0] neg_hi:[1,0,0]
    v_pk_fma_f32 v[98:99], v[180:181], v[142:143], v[98:99] neg_lo:[1,0,0] neg_hi:[1,0,0]
    v_pk_fma_f32 v[100:101], v[180:181], v[144:145], v[100:101] neg_lo:[1,0,0] neg_hi:[1,0,0]
    v_pk_mul_f32 v[94:95], v[94:95], v[182:183]
    v_pk_mul_f32 v[96:97], v[96:97], v[182:183]
    v_pk_mul_f32 v[98:99], v[98:99], v[182:183]
    v_pk_mul_f32 v[100:101], v[100:101], v[182:183]
    v_cvt_pk_bf16_f32 v184, v94, v95
    v_cvt_pk_bf16_f32 v185, v96, v97
    ds_write_b64 v254, v[184:185] offset:0
    v_cvt_pk_bf16_f32 v186, v98, v99
    v_cvt_pk_bf16_f32 v187, v100, v101
    ds_write_b64 v254, v[186:187] offset:32
L_sequ_q3_19:
    s_cmp_eq_u64 s[76:77], 0
    s_cbranch_scc1 L_sequ_kv2_29
    s_mov_b32 s50, 22553600
    s_mov_b32 s78, 0
L_sequ_poll_30:
    buffer_load_dwordx4 v[196:199], v2, s[4:7], s50 offen sc1
    s_add_u32 s78, s78, 1
    s_waitcnt vmcnt(0)
    v_xor_b32 v196, s34, v196
    v_xor_b32 v197, s34, v197
    v_xor_b32 v198, s34, v198
    v_xor_b32 v199, s34, v199
    v_or3_b32 v196, v196, v197, v198
    v_or_b32 v196, v196, v199
    v_cmp_lt_u32 vcc, 7, v196
    s_cmp_gt_u32 s78, 0x40000
    s_cbranch_scc1 L_sequ_polld_31
    s_cbranch_vccnz L_sequ_poll_30
L_sequ_polld_31:
    s_mov_b64 exec, -1
    s_add_u32 m0, s30, 0
    s_add_u32 s65, m0, 2621440
    buffer_load_dwordx4 v2, s[4:7], s65 offen sc1 lds
    s_add_u32 m0, s32, 16384
    s_nop 0
    buffer_load_dwordx4 v2, s[4:7], s33 offen offset:0 sc1 lds
    buffer_load_dwordx4 v2, s[4:7], s33 offen offset:1024 sc1 lds
    s_add_u32 m0, s31, 0
    s_add_u32 s65, m0, 2621440
    buffer_load_dwordx4 v2, s[4:7], s65 offen sc1 lds
L_sequ_kv2_29:
    v_cmp_ne_u32 vcc, 0, v196
    s_lshl_b32 s50, s80, 2
    s_lshr_b64 s[76:77], vcc, s50
    s_and_b32 s76, s76, 15
    s_cselect_b32 s35, 0, 1
    s_add_u32 m0, s31, 4096
    s_add_u32 s65, m0, 2621440
    buffer_load_dwordx4 v2, s[4:7], s65 offen sc1 lds
    s_add_u32 m0, s30, 4096
    s_add_u32 s65, m0, 2621440
    buffer_load_dwordx4 v2, s[4:7], s65 offen sc1 lds
    s_or_b32 s50, s26, s20
    s_cbranch_scc1 L_sequ_ep_32
    s_mov_b32 s50, 22554624
    v_mov_b32 v11, 0
    v_mov_b32 v12, s3
    s_mov_b64 exec, 1
    buffer_store_dword v12, v11, s[4:7], s50 offen sc1
    s_mov_b64 exec, -1
L_sequ_ep_32:
    s_waitcnt vmcnt(2)
    s_waitcnt lgkmcnt(0)
    s_barrier
    s_setprio 3
    ds_read_b64 v[166:167], v200 offset:32
    ds_read_b128 v[196:199], v20 offset:16384
    ds_read_b64 v[158:159], v255 offset:0
    ds_read_b64 v[160:161], v255 offset:8
    ds_read_b64 v[162:163], v255 offset:5632
    ds_read_b64 v[164:165], v255 offset:5640
    ds_read_b128 v[184:187], v20 offset:0
    ds_read_b128 v[188:191], v21 offset:0
    s_waitcnt lgkmcnt(6)
    v_mfma_f32_32x32x4_2b_bf16 v[30:61], v[196:197], v[166:167], 0 cbsz:1 abid:0
    s_add_u32 m0, s31, 8192
    s_add_u32 s65, m0, 2621440
    buffer_load_dwordx4 v2, s[4:7], s65 offen sc1 lds
    s_add_u32 m0, s30, 8192
    s_add_u32 s65, m0, 2621440
    buffer_load_dwordx4 v2, s[4:7], s65 offen sc1 lds
    s_add_u32 m0, s31, 12288
    s_add_u32 s65, m0, 2621440
    buffer_load_dwordx4 v2, s[4:7], s65 offen sc1 lds
    s_waitcnt lgkmcnt(1)
    s_nop 7
    v_mfma_f32_32x32x16_bf16 v[30:45], v[184:187], v[158:161], v[30:45]
    v_mfma_f32_32x32x16_bf16 v[46:61], v[184:187], v[162:165], v[46:61]
    ds_read_b128 v[184:187], v20 offset:1024
    ds_read_b128 v[200:203], v20 offset:17408
    ds_read_b128 v[204:207], v20 offset:18432
    ds_read_b128 v[208:211], v20 offset:19456
    ds_read_b128 v[212:215], v20 offset:20480
    ds_read_b128 v[216:219], v20 offset:21504
    ds_read_b128 v[220:223], v20 offset:22528
    ds_read_b128 v[224:227], v20 offset:23552
    s_setprio 2
    v_mov_b32 v168, 0x3f80
    v_mov_b32 v169, 0
    v_mov_b32 v171, 0
    s_mov_b32 s76, 0
    s_mov_b32 s77, -1
    v_max3_f32 v22, v30, v31, v32
    v_max3_f32 v22, v22, v33, v34
    v_max3_f32 v22, v22, v35, v36
    v_max3_f32 v22, v22, v37, v38
    v_max3_f32 v22, v22, v39, v40
    v_max3_f32 v22, v22, v41, v42
    v_max3_f32 v22, v22, v43, v44
    v_max_f32 v22, v22, v45
    v_max3_f32 v23, v46, v47, v48
    v_max3_f32 v23, v23, v49, v50
    v_max3_f32 v23, v23, v51, v52
    v_max3_f32 v23, v23, v53, v54
    v_max3_f32 v23, v23, v55, v56
    v_max3_f32 v23, v23, v57, v58
    v_max3_f32 v23, v23, v59, v60
    v_max_f32 v23, v23, v61
    v_mov_b32 v5, v22
    v_mov_b32 v6, v23
    s_nop 0
    v_permlane32_swap_b32 v22, v5
    v_permlane32_swap_b32 v23, v6
    v_max_f32 v22, v22, v5
    v_max_f32 v23, v23, v6
    v_cvt_pk_bf16_f32 v5, v22, 0
    v_cvt_pk_bf16_f32 v6, v23, 0
    v_cndmask_b32 v170, v5, v6, s[76:77]
    v_xor_b32 v170, 0x8000, v170
    v_lshlrev_b32 v22, 16, v5
    v_lshlrev_b32 v23, 16, v6
    v_mfma_f32_32x32x4_2b_bf16 v[30:61], v[168:169], v[170:171], v[30:61]
    v_mfma_f32_32x32x4_2b_bf16 v[94:125], v[168:169], v[170:171], 0
    s_waitcnt lgkmcnt(0)
    v_mfma_f32_32x32x4_2b_bf16 v[62:93], v[196:197], v[166:167], v[94:125] cbsz:1 abid:1
    s_setprio 1
    v_lshrrev_b32 v7, 5, v1
    s_add_u32 m0, s81, 0
    v_mad_u32_u24 v8, v7, s69, v26
    buffer_load_dwordx4 v8, s[8:11], s68 offen lds
    s_add_u32 m0, s81, 1024
    v_mad_u32_u24 v8, v7, s71, v26
    buffer_load_dwordx4 v8, s[8:11], s70 offen lds
    s_add_u32 m0, s81, 2048
    v_mad_u32_u24 v8, v7, s73, v26
    buffer_load_dwordx4 v8, s[8:11], s72 offen lds
    s_add_u32 m0, s81, 3072
    v_mad_u32_u24 v8, v7, s75, v26
    buffer_load_dwordx4 v8, s[8:11], s74 offen lds
    s_nop 2
    v_exp_f32 v30, v30
    v_exp_f32 v31, v31
    v_exp_f32 v32, v32
    v_exp_f32 v33, v33
    v_cvt_pk_bf16_f32 v168, v30, v31
    v_cvt_pk_bf16_f32 v169, v32, v33
    v_exp_f32 v34, v34
    v_exp_f32 v35, v35
    v_exp_f32 v36, v36
    v_exp_f32 v37, v37
    v_cvt_pk_bf16_f32 v170, v34, v35
    v_cvt_pk_bf16_f32 v171, v36, v37
    ds_read_b128 v[192:195], v21 offset:672
    v_exp_f32 v38, v38
    v_exp_f32 v39, v39
    v_exp_f32 v40, v40
    v_exp_f32 v41, v41
    v_cvt_pk_bf16_f32 v172, v38, v39
    v_cvt_pk_bf16_f32 v173, v40, v41
    s_waitcnt lgkmcnt(1)
    v_mfma_f32_32x32x16_bf16 v[126:141], v[188:191], v[168:171], 0
    v_exp_f32 v42, v42
    v_exp_f32 v43, v43
    v_exp_f32 v44, v44
    v_exp_f32 v45, v45
    v_cvt_pk_bf16_f32 v174, v42, v43
    v_cvt_pk_bf16_f32 v175, v44, v45
    v_mfma_f32_32x32x16_bf16 v[62:77], v[184:187], v[158:161], v[62:77]
    v_exp_f32 v46, v46
    v_exp_f32 v47, v47
    v_exp_f32 v48, v48
    v_exp_f32 v49, v49
    v_cvt_pk_bf16_f32 v176, v46, v47
    v_cvt_pk_bf16_f32 v177, v48, v49
    s_waitcnt lgkmcnt(0)
    v_mfma_f32_32x32x16_bf16 v[126:141], v[192:195], v[172:175], v[126:141]
    v_exp_f32 v50, v50
    v_exp_f32 v51, v51
    v_exp_f32 v52, v52
    v_exp_f32 v53, v53
    v_cvt_pk_bf16_f32 v178, v50, v51
    v_cvt_pk_bf16_f32 v179, v52, v53
    v_mfma_f32_32x32x16_bf16 v[78:93], v[184:187], v[162:165], v[78:93]
    ds_read_b128 v[184:187], v20 offset:2048
    v_exp_f32 v54, v54
    v_exp_f32 v55, v55
    v_exp_f32 v56, v56
    v_exp_f32 v57, v57
    v_cvt_pk_bf16_f32 v180, v54, v55
    v_cvt_pk_bf16_f32 v181, v56, v57
    v_mfma_f32_32x32x16_bf16 v[142:157], v[188:191], v[176:179], 0
    ds_read_b128 v[188:191], v21 offset:1344
    v_exp_f32 v58, v58
    v_exp_f32 v59, v59
    v_exp_f32 v60, v60
    v_exp_f32 v61, v61
    v_cvt_pk_bf16_f32 v182, v58, v59
    v_cvt_pk_bf16_f32 v183, v60, v61
    v_mfma_f32_32x32x4_2b_bf16 v[30:61], v[198:199], v[166:167], v[94:125] cbsz:1 abid:0
    s_setprio 0
    v_exp_f32 v62, v62
    v_exp_f32 v63, v63
    v_exp_f32 v64, v64
    v_exp_f32 v65, v65
    v_cvt_pk_bf16_f32 v168, v62, v63
    v_cvt_pk_bf16_f32 v169, v64, v65
    v_exp_f32 v66, v66
    v_exp_f32 v67, v67
    v_exp_f32 v68, v68
    v_exp_f32 v69, v69
    v_cvt_pk_bf16_f32 v170, v66, v67
    v_cvt_pk_bf16_f32 v171, v68, v69
    v_mfma_f32_32x32x16_bf16 v[142:157], v[192:195], v[180:183], v[142:157]
    ds_read_b128 v[192:195], v21 offset:2016
    v_exp_f32 v70, v70
    v_exp_f32 v71, v71
    v_exp_f32 v72, v72
    v_exp_f32 v73, v73
    v_cvt_pk_bf16_f32 v172, v70, v71
    v_cvt_pk_bf16_f32 v173, v72, v73
    s_waitcnt lgkmcnt(1)
    v_mfma_f32_32x32x16_bf16 v[126:141], v[188:191], v[168:171], v[126:141]
    v_exp_f32 v74, v74
    v_exp_f32 v75, v75
    v_exp_f32 v76, v76
    v_exp_f32 v77, v77
    v_cvt_pk_bf16_f32 v174, v74, v75
    v_cvt_pk_bf16_f32 v175, v76, v77
    v_mfma_f32_32x32x16_bf16 v[30:45], v[184:187], v[158:161], v[30:45]
    v_exp_f32 v78, v78
    v_exp_f32 v79, v79
    v_exp_f32 v80, v80
    v_exp_f32 v81, v81
    v_cvt_pk_bf16_f32 v176, v78, v79
    v_cvt_pk_bf16_f32 v177, v80, v81
    s_waitcnt lgkmcnt(0)
    v_mfma_f32_32x32x16_bf16 v[126:141], v[192:195], v[172:175], v[126:141]
    v_exp_f32 v82, v82
    v_exp_f32 v83, v83
    v_exp_f32 v84, v84
    v_exp_f32 v85, v85
    v_cvt_pk_bf16_f32 v178, v82, v83
    v_cvt_pk_bf16_f32 v179, v84, v85
    v_mfma_f32_32x32x16_bf16 v[46:61], v[184:187], v[162:165], v[46:61]
    ds_read_b128 v[184:187], v20 offset:3072
    v_exp_f32 v86, v86
    v_exp_f32 v87, v87
    v_exp_f32 v88, v88
    v_exp_f32 v89, v89
    v_cvt_pk_bf16_f32 v180, v86, v87
    v_cvt_pk_bf16_f32 v181, v88, v89
    v_mfma_f32_32x32x16_bf16 v[142:157], v[188:191], v[176:179], v[142:157]
    ds_read_b128 v[188:191], v21 offset:2688
    v_exp_f32 v90, v90
    v_exp_f32 v91, v91
    v_exp_f32 v92, v92
    v_exp_f32 v93, v93
    v_cvt_pk_bf16_f32 v182, v90, v91
    v_cvt_pk_bf16_f32 v183, v92, v93
    s_waitcnt vmcnt(5)
    s_barrier
    v_mfma_f32_32x32x4_2b_bf16 v[62:93], v[198:199], v[166:167], v[94:125] cbsz:1 abid:1
    s_setprio 3
    s_add_u32 m0, s29, 12288
    s_add_u32 s65, m0, 2621440
    v_exp_f32 v30, v30
    v_exp_f32 v31, v31
    v_exp_f32 v32, v32
    v_exp_f32 v33, v33
    v_cvt_pk_bf16_f32 v168, v30, v31
    v_cvt_pk_bf16_f32 v169, v32, v33
    v_exp_f32 v34, v34
    v_exp_f32 v35, v35
    v_exp_f32 v36, v36
    v_exp_f32 v37, v37
    v_cvt_pk_bf16_f32 v170, v34, v35
    v_cvt_pk_bf16_f32 v171, v36, v37
    v_mfma_f32_32x32x16_bf16 v[142:157], v[192:195], v[180:183], v[142:157]
    ds_read_b128 v[192:195], v21 offset:3360
    v_exp_f32 v38, v38
    v_exp_f32 v39, v39
    v_exp_f32 v40, v40
    v_exp_f32 v41, v41
    v_cvt_pk_bf16_f32 v172, v38, v39
    v_cvt_pk_bf16_f32 v173, v40, v41
    s_waitcnt lgkmcnt(1)
    v_mfma_f32_32x32x16_bf16 v[126:141], v[188:191], v[168:171], v[126:141]
    buffer_load_dwordx4 v2, s[4:7], s65 offen offset:0 sc1 lds
    v_exp_f32 v42, v42
    v_exp_f32 v43, v43
    v_exp_f32 v44, v44
    v_exp_f32 v45, v45
    v_cvt_pk_bf16_f32 v174, v42, v43
    v_cvt_pk_bf16_f32 v175, v44, v45
    v_mfma_f32_32x32x16_bf16 v[62:77], v[184:187], v[158:161], v[62:77]
    buffer_load_dwordx4 v2, s[4:7], s65 offen offset:1024 sc1 lds
    v_exp_f32 v46, v46
    v_exp_f32 v47, v47
    v_exp_f32 v48, v48
    v_exp_f32 v49, v49
    v_cvt_pk_bf16_f32 v176, v46, v47
    v_cvt_pk_bf16_f32 v177, v48, v49
    s_waitcnt lgkmcnt(0)
    v_mfma_f32_32x32x16_bf16 v[126:141], v[192:195], v[172:175], v[126:141]
    buffer_load_dwordx4 v2, s[4:7], s65 offen offset:2048 sc1 lds
    v_exp_f32 v50, v50
    v_exp_f32 v51, v51
    v_exp_f32 v52, v52
    v_exp_f32 v53, v53
    v_cvt_pk_bf16_f32 v178, v50, v51
    v_cvt_pk_bf16_f32 v179, v52, v53
    v_mfma_f32_32x32x16_bf16 v[78:93], v[184:187], v[162:165], v[78:93]
    ds_read_b128 v[184:187], v20 offset:4096
    v_exp_f32 v54, v54
    v_exp_f32 v55, v55
    v_exp_f32 v56, v56
    v_exp_f32 v57, v57
    v_cvt_pk_bf16_f32 v180, v54, v55
    v_cvt_pk_bf16_f32 v181, v56, v57
    v_mfma_f32_32x32x16_bf16 v[142:157], v[188:191], v[176:179], v[142:157]
    ds_read_b128 v[188:191], v21 offset:4032
    v_exp_f32 v58, v58
    v_exp_f32 v59, v59
    v_exp_f32 v60, v60
    v_exp_f32 v61, v61
    v_cvt_pk_bf16_f32 v182, v58, v59
    v_cvt_pk_bf16_f32 v183, v60, v61
    v_mfma_f32_32x32x4_2b_bf16 v[30:61], v[200:201], v[166:167], v[94:125] cbsz:1 abid:0
    s_add_u32 m0, s56, 16384
    s_add_u32 s65, m0, 2621440
    v_exp_f32 v62, v62
    v_exp_f32 v63, v63
    v_exp_f32 v64, v64
    v_exp_f32 v65, v65
    v_cvt_pk_bf16_f32 v168, v62, v63
    v_cvt_pk_bf16_f32 v169, v64, v65
    v_exp_f32 v66, v66
    v_exp_f32 v67, v67
    v_exp_f32 v68, v68
    v_exp_f32 v69, v69
    v_cvt_pk_bf16_f32 v170, v66, v67
    v_cvt_pk_bf16_f32 v171, v68, v69
    v_mfma_f32_32x32x16_bf16 v[142:157], v[192:195], v[180:183], v[142:157]
    ds_read_b128 v[192:195], v21 offset:4704
    v_exp_f32 v70, v70
    v_exp_f32 v71, v71
    v_exp_f32 v72, v72
    v_exp_f32 v73, v73
    v_cvt_pk_bf16_f32 v172, v70, v71
    v_cvt_pk_bf16_f32 v173, v72, v73
    s_waitcnt lgkmcnt(1)
    v_mfma_f32_32x32x16_bf16 v[126:141], v[188:191], v[168:171], v[126:141]
    buffer_load_dwordx4 v2, s[4:7], s65 offen offset:0 sc1 lds
    v_exp_f32 v74, v74
    v_exp_f32 v75, v75
    v_exp_f32 v76, v76
    v_exp_f32 v77, v77
    v_cvt_pk_bf16_f32 v174, v74, v75
    v_cvt_pk_bf16_f32 v175, v76, v77
    v_mfma_f32_32x32x16_bf16 v[30:45], v[184:187], v[158:161], v[30:45]
    buffer_load_dwordx4 v2, s[4:7], s65 offen offset:1024 sc1 lds
    v_exp_f32 v78, v78
    v_exp_f32 v79, v79
    v_exp_f32 v80, v80
    v_exp_f32 v81, v81
    v_cvt_pk_bf16_f32 v176, v78, v79
    v_cvt_pk_bf16_f32 v177, v80, v81
    s_waitcnt lgkmcnt(0)
    v_mfma_f32_32x32x16_bf16 v[126:141], v[192:195], v[172:175], v[126:141]
    buffer_load_dwordx4 v2, s[4:7], s65 offen offset:2048 sc1 lds
    v_exp_f32 v82, v82
    v_exp_f32 v83, v83
    v_exp_f32 v84, v84
    v_exp_f32 v85, v85
    v_cvt_pk_bf16_f32 v178, v82, v83
    v_cvt_pk_bf16_f32 v179, v84, v85
    v_mfma_f32_32x32x16_bf16 v[46:61], v[184:187], v[162:165], v[46:61]
    ds_read_b128 v[184:187], v20 offset:5120
    v_exp_f32 v86, v86
    v_exp_f32 v87, v87
    v_exp_f32 v88, v88
    v_exp_f32 v89, v89
    v_cvt_pk_bf16_f32 v180, v86, v87
    v_cvt_pk_bf16_f32 v181, v88, v89
    v_mfma_f32_32x32x16_bf16 v[142:157], v[188:191], v[176:179], v[142:157]
    ds_read_b128 v[188:191], v21 offset:5376
    v_exp_f32 v90, v90
    v_exp_f32 v91, v91
    v_exp_f32 v92, v92
    v_exp_f32 v93, v93
    v_cvt_pk_bf16_f32 v182, v90, v91
    v_cvt_pk_bf16_f32 v183, v92, v93
    v_mfma_f32_32x32x4_2b_bf16 v[62:93], v[200:201], v[166:167], v[94:125] cbsz:1 abid:1
    s_setprio 2
    buffer_load_dwordx4 v2, s[4:7], s65 offen offset:3072 sc1 lds
    v_exp_f32 v30, v30
    v_exp_f32 v31, v31
    v_exp_f32 v32, v32
    v_exp_f32 v33, v33
    v_cvt_pk_bf16_f32 v168, v30, v31
    v_cvt_pk_bf16_f32 v169, v32, v33
    v_exp_f32 v34, v34
    v_exp_f32 v35, v35
    v_exp_f32 v36, v36
    v_exp_f32 v37, v37
    v_cvt_pk_bf16_f32 v170, v34, v35
    v_cvt_pk_bf16_f32 v171, v36, v37
    v_mfma_f32_32x32x16_bf16 v[142:157], v[192:195], v[180:183], v[142:157]
    ds_read_b128 v[192:195], v21 offset:6048
    v_exp_f32 v38, v38
    v_exp_f32 v39, v39
    v_exp_f32 v40, v40
    v_exp_f32 v41, v41
    v_cvt_pk_bf16_f32 v172, v38, v39
    v_cvt_pk_bf16_f32 v173, v40, v41
    s_waitcnt lgkmcnt(1)
    v_mfma_f32_32x32x16_bf16 v[126:141], v[188:191], v[168:171], v[126:141]
    v_exp_f32 v42, v42
    v_exp_f32 v43, v43
    v_exp_f32 v44, v44
    v_exp_f32 v45, v45
    v_cvt_pk_bf16_f32 v174, v42, v43
    v_cvt_pk_bf16_f32 v175, v44, v45
    v_mfma_f32_32x32x16_bf16 v[62:77], v[184:187], v[158:161], v[62:77]
    v_exp_f32 v46, v46
    v_exp_f32 v47, v47
    v_exp_f32 v48, v48
    v_exp_f32 v49, v49
    v_cvt_pk_bf16_f32 v176, v46, v47
    v_cvt_pk_bf16_f32 v177, v48, v49
    s_waitcnt lgkmcnt(0)
    v_mfma_f32_32x32x16_bf16 v[126:141], v[192:195], v[172:175], v[126:141]
    v_exp_f32 v50, v50
    v_exp_f32 v51, v51
    v_exp_f32 v52, v52
    v_exp_f32 v53, v53
    v_cvt_pk_bf16_f32 v178, v50, v51
    v_cvt_pk_bf16_f32 v179, v52, v53
    v_mfma_f32_32x32x16_bf16 v[78:93], v[184:187], v[162:165], v[78:93]
    ds_read_b128 v[184:187], v20 offset:6144
    v_exp_f32 v54, v54
    v_exp_f32 v55, v55
    v_exp_f32 v56, v56
    v_exp_f32 v57, v57
    v_cvt_pk_bf16_f32 v180, v54, v55
    v_cvt_pk_bf16_f32 v181, v56, v57
    v_mfma_f32_32x32x16_bf16 v[142:157], v[188:191], v[176:179], v[142:157]
    ds_read_b128 v[188:191], v21 offset:6720
    v_exp_f32 v58, v58
    v_exp_f32 v59, v59
    v_exp_f32 v60, v60
    v_exp_f32 v61, v61
    v_cvt_pk_bf16_f32 v182, v58, v59
    v_cvt_pk_bf16_f32 v183, v60, v61
    v_mfma_f32_32x32x4_2b_bf16 v[30:61], v[202:203], v[166:167], v[94:125] cbsz:1 abid:0
    s_setprio 1
    v_exp_f32 v62, v62
    v_exp_f32 v63, v63
    v_exp_f32 v64, v64
    v_exp_f32 v65, v65
    v_cvt_pk_bf16_f32 v168, v62, v63
    v_cvt_pk_bf16_f32 v169, v64, v65
    v_exp_f32 v66, v66
    v_exp_f32 v67, v67
    v_exp_f32 v68, v68
    v_exp_f32 v69, v69
    v_cvt_pk_bf16_f32 v170, v66, v67
    v_cvt_pk_bf16_f32 v171, v68, v69
    v_mfma_f32_32x32x16_bf16 v[142:157], v[192:195], v[180:183], v[142:157]
    ds_read_b128 v[192:195], v21 offset:7392
    v_exp_f32 v70, v70
    v_exp_f32 v71, v71
    v_exp_f32 v72, v72
    v_exp_f32 v73, v73
    v_cvt_pk_bf16_f32 v172, v70, v71
    v_cvt_pk_bf16_f32 v173, v72, v73
    s_waitcnt lgkmcnt(1)
    v_mfma_f32_32x32x16_bf16 v[126:141], v[188:191], v[168:171], v[126:141]
    v_exp_f32 v74, v74
    v_exp_f32 v75, v75
    v_exp_f32 v76, v76
    v_exp_f32 v77, v77
    v_cvt_pk_bf16_f32 v174, v74, v75
    v_cvt_pk_bf16_f32 v175, v76, v77
    v_mfma_f32_32x32x16_bf16 v[30:45], v[184:187], v[158:161], v[30:45]
    v_exp_f32 v78, v78
    v_exp_f32 v79, v79
    v_exp_f32 v80, v80
    v_exp_f32 v81, v81
    v_cvt_pk_bf16_f32 v176, v78, v79
    v_cvt_pk_bf16_f32 v177, v80, v81
    s_waitcnt lgkmcnt(0)
    v_mfma_f32_32x32x16_bf16 v[126:141], v[192:195], v[172:175], v[126:141]
    v_exp_f32 v82, v82
    v_exp_f32 v83, v83
    v_exp_f32 v84, v84
    v_exp_f32 v85, v85
    v_cvt_pk_bf16_f32 v178, v82, v83
    v_cvt_pk_bf16_f32 v179, v84, v85
    v_mfma_f32_32x32x16_bf16 v[46:61], v[184:187], v[162:165], v[46:61]
    ds_read_b128 v[184:187], v20 offset:7168
    v_exp_f32 v86, v86
    v_exp_f32 v87, v87
    v_exp_f32 v88, v88
    v_exp_f32 v89, v89
    v_cvt_pk_bf16_f32 v180, v86, v87
    v_cvt_pk_bf16_f32 v181, v88, v89
    v_mfma_f32_32x32x16_bf16 v[142:157], v[188:191], v[176:179], v[142:157]
    ds_read_b128 v[188:191], v21 offset:8064
    v_exp_f32 v90, v90
    v_exp_f32 v91, v91
    v_exp_f32 v92, v92
    v_exp_f32 v93, v93
    v_cvt_pk_bf16_f32 v182, v90, v91
    v_cvt_pk_bf16_f32 v183, v92, v93
    v_mfma_f32_32x32x4_2b_bf16 v[62:93], v[202:203], v[166:167], v[94:125] cbsz:1 abid:1
    s_waitcnt vmcnt(0)
    s_cmp_ge_u32 s20, 5
    s_cbranch_scc1 L_sequ_o5_33
    ds_read_b64_tr_b16 v[228:229], v28 offset:0
    ds_read_b64_tr_b16 v[230:231], v28 offset:512
    ds_read_b64_tr_b16 v[232:233], v28 offset:1024
    ds_read_b64_tr_b16 v[234:235], v28 offset:1536
    ds_read_b64_tr_b16 v[236:237], v28 offset:2048
    ds_read_b64_tr_b16 v[238:239], v28 offset:2560
    ds_read_b64_tr_b16 v[240:241], v28 offset:3072
    ds_read_b64_tr_b16 v[242:243], v28 offset:3584
    v_cmp_eq_u32 vcc, v3, v4
    v_mov_b32 v5, 0x3f803f80
    v_lshlrev_b32 v10, 6, v3
    v_cndmask_b32 v6, 0, v5, vcc
    v_cndmask_b32 v7, 0, v5, vcc
    v_cndmask_b32 v8, 0, v5, vcc
    v_cndmask_b32 v9, 0, v5, vcc
    v_lshl_add_u32 v10, v4, 4, v10
    s_waitcnt lgkmcnt(0)
    v_mfma_f32_16x16x32_bf16 v[248:251], v[228:231], v[6:9], 0
    v_mfma_f32_16x16x32_bf16 v[248:251], v[232:235], v[6:9], v[248:251]
    v_mfma_f32_16x16x32_bf16 v[248:251], v[236:239], v[6:9], v[248:251]
    v_mfma_f32_16x16x32_bf16 v[248:251], v[240:243], v[6:9], v[248:251]
    buffer_store_dwordx4 v[228:231], v27, s[4:7], 0 offen offset:0 sc1
    buffer_store_dwordx4 v[232:235], v27, s[4:7], 0 offen offset:256 sc1
    buffer_store_dwordx4 v[236:239], v27, s[4:7], 0 offen offset:512 sc1
    buffer_store_dwordx4 v[240:243], v27, s[4:7], 0 offen offset:768 sc1
    s_mov_b32 exec_lo, 0x000f000f
    s_mov_b32 exec_hi, 0x000f000f
    s_nop 1
    buffer_store_dwordx4 v[248:251], v10, s[4:7], s19 offen sc1
    s_mov_b64 exec, -1
L_sequ_o5_33:
    v_exp_f32 v30, v30
    v_exp_f32 v31, v31
    v_exp_f32 v32, v32
    v_exp_f32 v33, v33
    v_cvt_pk_bf16_f32 v168, v30, v31
    v_cvt_pk_bf16_f32 v169, v32, v33
    v_exp_f32 v34, v34
    v_exp_f32 v35, v35
    v_exp_f32 v36, v36
    v_exp_f32 v37, v37
    v_cvt_pk_bf16_f32 v170, v34, v35
    v_cvt_pk_bf16_f32 v171, v36, v37
    v_mfma_f32_32x32x16_bf16 v[142:157], v[192:195], v[180:183], v[142:157]
    ds_read_b128 v[192:195], v21 offset:8736
    v_exp_f32 v38, v38
    v_exp_f32 v39, v39
    v_exp_f32 v40, v40
    v_exp_f32 v41, v41
    v_cvt_pk_bf16_f32 v172, v38, v39
    v_cvt_pk_bf16_f32 v173, v40, v41
    s_waitcnt lgkmcnt(1)
    v_mfma_f32_32x32x16_bf16 v[126:141], v[188:191], v[168:171], v[126:141]
    s_cmp_lg_u32 s20, 5
    s_cbranch_scc1 L_sequ_zp_34
    s_cmp_ge_u32 s26, 20
    s_cbranch_scc1 L_sequ_zp_34
    v_mov_b32 v228, 0
    v_mov_b32 v229, 0
    v_mov_b32 v230, 0
    v_mov_b32 v231, 0
    s_mul_i32 s50, s26, 7168
    s_add_u32 s51, s50, 22289152
    s_add_u32 s50, s50, 18929664
    buffer_store_dwordx4 v[228:231], v2, s[4:7], s50 offen offset:0 sc1
    buffer_store_dwordx4 v[228:231], v2, s[4:7], s50 offen offset:1024 sc1
    buffer_store_dwordx4 v[228:231], v2, s[4:7], s50 offen offset:2048 sc1
    buffer_store_dwordx4 v[228:231], v2, s[4:7], s50 offen offset:3072 sc1
    s_mov_b64 exec, 0xffff
    buffer_store_dwordx4 v[228:231], v2, s[4:7], s51 offen sc1
    s_mov_b64 exec, -1
L_sequ_zp_34:
    v_exp_f32 v42, v42
    v_exp_f32 v43, v43
    v_exp_f32 v44, v44
    v_exp_f32 v45, v45
    v_cvt_pk_bf16_f32 v174, v42, v43
    v_cvt_pk_bf16_f32 v175, v44, v45
    v_mfma_f32_32x32x16_bf16 v[62:77], v[184:187], v[158:161], v[62:77]
    v_exp_f32 v46, v46
    v_exp_f32 v47, v47
    v_exp_f32 v48, v48
    v_exp_f32 v49, v49
    v_cvt_pk_bf16_f32 v176, v46, v47
    v_cvt_pk_bf16_f32 v177, v48, v49
    s_waitcnt lgkmcnt(0)
    v_mfma_f32_32x32x16_bf16 v[126:141], v[192:195], v[172:175], v[126:141]
    v_exp_f32 v50, v50
    v_exp_f32 v51, v51
    v_exp_f32 v52, v52
    v_exp_f32 v53, v53
    v_cvt_pk_bf16_f32 v178, v50, v51
    v_cvt_pk_bf16_f32 v179, v52, v53
    v_mfma_f32_32x32x16_bf16 v[78:93], v[184:187], v[162:165], v[78:93]
    ds_read_b128 v[184:187], v20 offset:8192
    v_exp_f32 v54, v54
    v_exp_f32 v55, v55
    v_exp_f32 v56, v56
    v_exp_f32 v57, v57
    v_cvt_pk_bf16_f32 v180, v54, v55
    v_cvt_pk_bf16_f32 v181, v56, v57
    v_mfma_f32_32x32x16_bf16 v[142:157], v[188:191], v[176:179], v[142:157]
    ds_read_b128 v[188:191], v21 offset:9408
    v_exp_f32 v58, v58
    v_exp_f32 v59, v59
    v_exp_f32 v60, v60
    v_exp_f32 v61, v61
    v_cvt_pk_bf16_f32 v182, v58, v59
    v_cvt_pk_bf16_f32 v183, v60, v61
    v_mfma_f32_32x32x4_2b_bf16 v[30:61], v[204:205], v[166:167], v[94:125] cbsz:1 abid:0
    s_setprio 0
    v_exp_f32 v62, v62
    v_exp_f32 v63, v63
    v_exp_f32 v64, v64
    v_exp_f32 v65, v65
    v_cvt_pk_bf16_f32 v168, v62, v63
    v_cvt_pk_bf16_f32 v169, v64, v65
    v_exp_f32 v66, v66
    v_exp_f32 v67, v67
    v_exp_f32 v68, v68
    v_exp_f32 v69, v69
    v_cvt_pk_bf16_f32 v170, v66, v67
    v_cvt_pk_bf16_f32 v171, v68, v69
    v_mfma_f32_32x32x16_bf16 v[142:157], v[192:195], v[180:183], v[142:157]
    ds_read_b128 v[192:195], v21 offset:10080
    v_exp_f32 v70, v70
    v_exp_f32 v71, v71
    v_exp_f32 v72, v72
    v_exp_f32 v73, v73
    v_cvt_pk_bf16_f32 v172, v70, v71
    v_cvt_pk_bf16_f32 v173, v72, v73
    s_waitcnt lgkmcnt(1)
    v_mfma_f32_32x32x16_bf16 v[126:141], v[188:191], v[168:171], v[126:141]
    v_exp_f32 v74, v74
    v_exp_f32 v75, v75
    v_exp_f32 v76, v76
    v_exp_f32 v77, v77
    v_cvt_pk_bf16_f32 v174, v74, v75
    v_cvt_pk_bf16_f32 v175, v76, v77
    v_mfma_f32_32x32x16_bf16 v[30:45], v[184:187], v[158:161], v[30:45]
    v_exp_f32 v78, v78
    v_exp_f32 v79, v79
    v_exp_f32 v80, v80
    v_exp_f32 v81, v81
    v_cvt_pk_bf16_f32 v176, v78, v79
    v_cvt_pk_bf16_f32 v177, v80, v81
    s_waitcnt lgkmcnt(0)
    v_mfma_f32_32x32x16_bf16 v[126:141], v[192:195], v[172:175], v[126:141]
    v_exp_f32 v82, v82
    v_exp_f32 v83, v83
    v_exp_f32 v84, v84
    v_exp_f32 v85, v85
    v_cvt_pk_bf16_f32 v178, v82, v83
    v_cvt_pk_bf16_f32 v179, v84, v85
    v_mfma_f32_32x32x16_bf16 v[46:61], v[184:187], v[162:165], v[46:61]
    ds_read_b128 v[184:187], v20 offset:9216
    v_exp_f32 v86, v86
    v_exp_f32 v87, v87
    v_exp_f32 v88, v88
    v_exp_f32 v89, v89
    v_cvt_pk_bf16_f32 v180, v86, v87
    v_cvt_pk_bf16_f32 v181, v88, v89
    v_mfma_f32_32x32x16_bf16 v[142:157], v[188:191], v[176:179], v[142:157]
    ds_read_b128 v[188:191], v21 offset:10752
    v_exp_f32 v90, v90
    v_exp_f32 v91, v91
    v_exp_f32 v92, v92
    v_exp_f32 v93, v93
    v_cvt_pk_bf16_f32 v182, v90, v91
    v_cvt_pk_bf16_f32 v183, v92, v93
    s_barrier
    v_mfma_f32_32x32x4_2b_bf16 v[62:93], v[204:205], v[166:167], v[94:125] cbsz:1 abid:1
    s_setprio 3
    s_add_u32 m0, s28, 24576
    s_add_u32 s65, m0, 2621440
    v_exp_f32 v30, v30
    v_exp_f32 v31, v31
    v_exp_f32 v32, v32
    v_exp_f32 v33, v33
    v_cvt_pk_bf16_f32 v168, v30, v31
    v_cvt_pk_bf16_f32 v169, v32, v33
    v_exp_f32 v34, v34
    v_exp_f32 v35, v35
    v_exp_f32 v36, v36
    v_exp_f32 v37, v37
    v_cvt_pk_bf16_f32 v170, v34, v35
    v_cvt_pk_bf16_f32 v171, v36, v37
    v_mfma_f32_32x32x16_bf16 v[142:157], v[192:195], v[180:183], v[142:157]
    ds_read_b128 v[192:195], v21 offset:11424
    v_exp_f32 v38, v38
    v_exp_f32 v39, v39
    v_exp_f32 v40, v40
    v_exp_f32 v41, v41
    v_cvt_pk_bf16_f32 v172, v38, v39
    v_cvt_pk_bf16_f32 v173, v40, v41
    s_waitcnt lgkmcnt(1)
    v_mfma_f32_32x32x16_bf16 v[126:141], v[188:191], v[168:171], v[126:141]
    buffer_load_dwordx4 v2, s[4:7], s65 offen offset:0 sc1 lds
    v_exp_f32 v42, v42
    v_exp_f32 v43, v43
    v_exp_f32 v44, v44
    v_exp_f32 v45, v45
    v_cvt_pk_bf16_f32 v174, v42, v43
    v_cvt_pk_bf16_f32 v175, v44, v45
    v_mfma_f32_32x32x16_bf16 v[62:77], v[184:187], v[158:161], v[62:77]
    buffer_load_dwordx4 v2, s[4:7], s65 offen offset:1024 sc1 lds
    v_exp_f32 v46, v46
    v_exp_f32 v47, v47
    v_exp_f32 v48, v48
    v_exp_f32 v49, v49
    v_cvt_pk_bf16_f32 v176, v46, v47
    v_cvt_pk_bf16_f32 v177, v48, v49
    s_waitcnt lgkmcnt(0)
    v_mfma_f32_32x32x16_bf16 v[126:141], v[192:195], v[172:175], v[126:141]
    s_add_u32 m0, s55, 32768
    s_add_u32 s65, m0, 2621440
    v_exp_f32 v50, v50
    v_exp_f32 v51, v51
    v_exp_f32 v52, v52
    v_exp_f32 v53, v53
    v_cvt_pk_bf16_f32 v178, v50, v51
    v_cvt_pk_bf16_f32 v179, v52, v53
    v_mfma_f32_32x32x16_bf16 v[78:93], v[184:187], v[162:165], v[78:93]
    ds_read_b128 v[184:187], v20 offset:10240
    v_exp_f32 v54, v54
    v_exp_f32 v55, v55
    v_exp_f32 v56, v56
    v_exp_f32 v57, v57
    v_cvt_pk_bf16_f32 v180, v54, v55
    v_cvt_pk_bf16_f32 v181, v56, v57
    v_mfma_f32_32x32x16_bf16 v[142:157], v[188:191], v[176:179], v[142:157]
    ds_read_b128 v[188:191], v21 offset:12096
    v_exp_f32 v58, v58
    v_exp_f32 v59, v59
    v_exp_f32 v60, v60
    v_exp_f32 v61, v61
    v_cvt_pk_bf16_f32 v182, v58, v59
    v_cvt_pk_bf16_f32 v183, v60, v61
    v_mfma_f32_32x32x4_2b_bf16 v[30:61], v[206:207], v[166:167], v[94:125] cbsz:1 abid:0
    buffer_load_dwordx4 v2, s[4:7], s65 offen offset:0 sc1 lds
    v_exp_f32 v62, v62
    v_exp_f32 v63, v63
    v_exp_f32 v64, v64
    v_exp_f32 v65, v65
    v_cvt_pk_bf16_f32 v168, v62, v63
    v_cvt_pk_bf16_f32 v169, v64, v65
    v_exp_f32 v66, v66
    v_exp_f32 v67, v67
    v_exp_f32 v68, v68
    v_exp_f32 v69, v69
    v_cvt_pk_bf16_f32 v170, v66, v67
    v_cvt_pk_bf16_f32 v171, v68, v69
    v_mfma_f32_32x32x16_bf16 v[142:157], v[192:195], v[180:183], v[142:157]
    ds_read_b128 v[192:195], v21 offset:12768
    v_exp_f32 v70, v70
    v_exp_f32 v71, v71
    v_exp_f32 v72, v72
    v_exp_f32 v73, v73
    v_cvt_pk_bf16_f32 v172, v70, v71
    v_cvt_pk_bf16_f32 v173, v72, v73
    s_waitcnt lgkmcnt(1)
    v_mfma_f32_32x32x16_bf16 v[126:141], v[188:191], v[168:171], v[126:141]
    buffer_load_dwordx4 v2, s[4:7], s65 offen offset:1024 sc1 lds
    v_exp_f32 v74, v74
    v_exp_f32 v75, v75
    v_exp_f32 v76, v76
    v_exp_f32 v77, v77
    v_cvt_pk_bf16_f32 v174, v74, v75
    v_cvt_pk_bf16_f32 v175, v76, v77
    v_mfma_f32_32x32x16_bf16 v[30:45], v[184:187], v[158:161], v[30:45]
    buffer_load_dwordx4 v2, s[4:7], s65 offen offset:2048 sc1 lds
    v_exp_f32 v78, v78
    v_exp_f32 v79, v79
    v_exp_f32 v80, v80
    v_exp_f32 v81, v81
    v_cvt_pk_bf16_f32 v176, v78, v79
    v_cvt_pk_bf16_f32 v177, v80, v81
    s_waitcnt lgkmcnt(0)
    v_mfma_f32_32x32x16_bf16 v[126:141], v[192:195], v[172:175], v[126:141]
    v_lshrrev_b32 v245, 2, v1
    v_lshlrev_b32 v245, 7, v245
    v_exp_f32 v82, v82
    v_exp_f32 v83, v83
    v_exp_f32 v84, v84
    v_exp_f32 v85, v85
    v_cvt_pk_bf16_f32 v178, v82, v83
    v_cvt_pk_bf16_f32 v179, v84, v85
    v_mfma_f32_32x32x16_bf16 v[46:61], v[184:187], v[162:165], v[46:61]
    ds_read_b128 v[184:187], v20 offset:11264
    v_exp_f32 v86, v86
    v_exp_f32 v87, v87
    v_exp_f32 v88, v88
    v_exp_f32 v89, v89
    v_cvt_pk_bf16_f32 v180, v86, v87
    v_cvt_pk_bf16_f32 v181, v88, v89
    v_mfma_f32_32x32x16_bf16 v[142:157], v[188:191], v[176:179], v[142:157]
    ds_read_b128 v[188:191], v21 offset:13440
    v_exp_f32 v90, v90
    v_exp_f32 v91, v91
    v_exp_f32 v92, v92
    v_exp_f32 v93, v93
    v_cvt_pk_bf16_f32 v182, v90, v91
    v_cvt_pk_bf16_f32 v183, v92, v93
    v_mfma_f32_32x32x4_2b_bf16 v[62:93], v[206:207], v[166:167], v[94:125] cbsz:1 abid:1
    s_setprio 2
    v_exp_f32 v30, v30
    v_exp_f32 v31, v31
    v_exp_f32 v32, v32
    v_exp_f32 v33, v33
    v_cvt_pk_bf16_f32 v168, v30, v31
    v_cvt_pk_bf16_f32 v169, v32, v33
    v_exp_f32 v34, v34
    v_exp_f32 v35, v35
    v_exp_f32 v36, v36
    v_exp_f32 v37, v37
    v_cvt_pk_bf16_f32 v170, v34, v35
    v_cvt_pk_bf16_f32 v171, v36, v37
    v_mfma_f32_32x32x16_bf16 v[142:157], v[192:195], v[180:183], v[142:157]
    ds_read_b128 v[192:195], v21 offset:14112
    v_exp_f32 v38, v38
    v_exp_f32 v39, v39
    v_exp_f32 v40, v40
    v_exp_f32 v41, v41
    v_cvt_pk_bf16_f32 v172, v38, v39
    v_cvt_pk_bf16_f32 v173, v40, v41
    s_waitcnt lgkmcnt(1)
    v_mfma_f32_32x32x16_bf16 v[126:141], v[188:191], v[168:171], v[126:141]
    v_exp_f32 v42, v42
    v_exp_f32 v43, v43
    v_exp_f32 v44, v44
    v_exp_f32 v45, v45
    v_cvt_pk_bf16_f32 v174, v42, v43
    v_cvt_pk_bf16_f32 v175, v44, v45
    v_mfma_f32_32x32x16_bf16 v[62:77], v[184:187], v[158:161], v[62:77]
    v_exp_f32 v46, v46
    v_exp_f32 v47, v47
    v_exp_f32 v48, v48
    v_exp_f32 v49, v49
    v_cvt_pk_bf16_f32 v176, v46, v47
    v_cvt_pk_bf16_f32 v177, v48, v49
    s_waitcnt lgkmcnt(0)
    v_mfma_f32_32x32x16_bf16 v[126:141], v[192:195], v[172:175], v[126:141]
    v_exp_f32 v50, v50
    v_exp_f32 v51, v51
    v_exp_f32 v52, v52
    v_exp_f32 v53, v53
    v_cvt_pk_bf16_f32 v178, v50, v51
    v_cvt_pk_bf16_f32 v179, v52, v53
    v_mfma_f32_32x32x16_bf16 v[78:93], v[184:187], v[162:165], v[78:93]
    ds_read_b128 v[184:187], v20 offset:12288
    v_exp_f32 v54, v54
    v_exp_f32 v55, v55
    v_exp_f32 v56, v56
    v_exp_f32 v57, v57
    v_cvt_pk_bf16_f32 v180, v54, v55
    v_cvt_pk_bf16_f32 v181, v56, v57
    v_mfma_f32_32x32x16_bf16 v[142:157], v[188:191], v[176:179], v[142:157]
    ds_read_b128 v[188:191], v21 offset:14784
    v_exp_f32 v58, v58
    v_exp_f32 v59, v59
    v_exp_f32 v60, v60
    v_exp_f32 v61, v61
    v_cvt_pk_bf16_f32 v182, v58, v59
    v_cvt_pk_bf16_f32 v183, v60, v61
    v_mfma_f32_32x32x4_2b_bf16 v[30:61], v[208:209], v[166:167], v[94:125] cbsz:1 abid:0
    s_setprio 1
    v_exp_f32 v62, v62
    v_exp_f32 v63, v63
    v_exp_f32 v64, v64
    v_exp_f32 v65, v65
    v_cvt_pk_bf16_f32 v168, v62, v63
    v_cvt_pk_bf16_f32 v169, v64, v65
    v_exp_f32 v66, v66
    v_exp_f32 v67, v67
    v_exp_f32 v68, v68
    v_exp_f32 v69, v69
    v_cvt_pk_bf16_f32 v170, v66, v67
    v_cvt_pk_bf16_f32 v171, v68, v69
    v_mfma_f32_32x32x16_bf16 v[142:157], v[192:195], v[180:183], v[142:157]
    ds_read_b128 v[192:195], v21 offset:15456
    v_exp_f32 v70, v70
    v_exp_f32 v71, v71
    v_exp_f32 v72, v72
    v_exp_f32 v73, v73
    v_cvt_pk_bf16_f32 v172, v70, v71
    v_cvt_pk_bf16_f32 v173, v72, v73
    s_waitcnt lgkmcnt(1)
    v_mfma_f32_32x32x16_bf16 v[126:141], v[188:191], v[168:171], v[126:141]
    v_exp_f32 v74, v74
    v_exp_f32 v75, v75
    v_exp_f32 v76, v76
    v_exp_f32 v77, v77
    v_cvt_pk_bf16_f32 v174, v74, v75
    v_cvt_pk_bf16_f32 v175, v76, v77
    v_mfma_f32_32x32x16_bf16 v[30:45], v[184:187], v[158:161], v[30:45]
    v_exp_f32 v78, v78
    v_exp_f32 v79, v79
    v_exp_f32 v80, v80
    v_exp_f32 v81, v81
    v_cvt_pk_bf16_f32 v176, v78, v79
    v_cvt_pk_bf16_f32 v177, v80, v81
    s_waitcnt lgkmcnt(0)
    v_mfma_f32_32x32x16_bf16 v[126:141], v[192:195], v[172:175], v[126:141]
    v_exp_f32 v82, v82
    v_exp_f32 v83, v83
    v_exp_f32 v84, v84
    v_exp_f32 v85, v85
    v_cvt_pk_bf16_f32 v178, v82, v83
    v_cvt_pk_bf16_f32 v179, v84, v85
    v_mfma_f32_32x32x16_bf16 v[46:61], v[184:187], v[162:165], v[46:61]
    ds_read_b128 v[184:187], v20 offset:13312
    v_exp_f32 v86, v86
    v_exp_f32 v87, v87
    v_exp_f32 v88, v88
    v_exp_f32 v89, v89
    v_cvt_pk_bf16_f32 v180, v86, v87
    v_cvt_pk_bf16_f32 v181, v88, v89
    v_mfma_f32_32x32x16_bf16 v[142:157], v[188:191], v[176:179], v[142:157]
    ds_read_b128 v[188:191], v21 offset:16128
    v_exp_f32 v90, v90
    v_exp_f32 v91, v91
    v_exp_f32 v92, v92
    v_exp_f32 v93, v93
    v_cvt_pk_bf16_f32 v182, v90, v91
    v_cvt_pk_bf16_f32 v183, v92, v93
    v_mfma_f32_32x32x4_2b_bf16 v[62:93], v[208:209], v[166:167], v[94:125] cbsz:1 abid:1
    v_exp_f32 v30, v30
    v_exp_f32 v31, v31
    v_exp_f32 v32, v32
    v_exp_f32 v33, v33
    v_cvt_pk_bf16_f32 v168, v30, v31
    v_cvt_pk_bf16_f32 v169, v32, v33
    v_exp_f32 v34, v34
    v_exp_f32 v35, v35
    v_exp_f32 v36, v36
    v_exp_f32 v37, v37
    v_cvt_pk_bf16_f32 v170, v34, v35
    v_cvt_pk_bf16_f32 v171, v36, v37
    v_mfma_f32_32x32x16_bf16 v[142:157], v[192:195], v[180:183], v[142:157]
    ds_read_b128 v[192:195], v21 offset:16800
    v_exp_f32 v38, v38
    v_exp_f32 v39, v39
    v_exp_f32 v40, v40
    v_exp_f32 v41, v41
    v_cvt_pk_bf16_f32 v172, v38, v39
    v_cvt_pk_bf16_f32 v173, v40, v41
    s_waitcnt lgkmcnt(1)
    v_mfma_f32_32x32x16_bf16 v[126:141], v[188:191], v[168:171], v[126:141]
    v_exp_f32 v42, v42
    v_exp_f32 v43, v43
    v_exp_f32 v44, v44
    v_exp_f32 v45, v45
    v_cvt_pk_bf16_f32 v174, v42, v43
    v_cvt_pk_bf16_f32 v175, v44, v45
    v_mfma_f32_32x32x16_bf16 v[62:77], v[184:187], v[158:161], v[62:77]
    v_exp_f32 v46, v46
    v_exp_f32 v47, v47
    v_exp_f32 v48, v48
    v_exp_f32 v49, v49
    v_cvt_pk_bf16_f32 v176, v46, v47
    v_cvt_pk_bf16_f32 v177, v48, v49
    s_waitcnt lgkmcnt(0)
    v_mfma_f32_32x32x16_bf16 v[126:141], v[192:195], v[172:175], v[126:141]
    v_exp_f32 v50, v50
    v_exp_f32 v51, v51
    v_exp_f32 v52, v52
    v_exp_f32 v53, v53
    v_cvt_pk_bf16_f32 v178, v50, v51
    v_cvt_pk_bf16_f32 v179, v52, v53
    v_mfma_f32_32x32x16_bf16 v[78:93], v[184:187], v[162:165], v[78:93]
    ds_read_b128 v[184:187], v20 offset:14336
    v_exp_f32 v54, v54
    v_exp_f32 v55, v55
    v_exp_f32 v56, v56
    v_exp_f32 v57, v57
    v_cvt_pk_bf16_f32 v180, v54, v55
    v_cvt_pk_bf16_f32 v181, v56, v57
    v_mfma_f32_32x32x16_bf16 v[142:157], v[188:191], v[176:179], v[142:157]
    ds_read_b128 v[188:191], v21 offset:17472
    v_exp_f32 v58, v58
    v_exp_f32 v59, v59
    v_exp_f32 v60, v60
    v_exp_f32 v61, v61
    v_cvt_pk_bf16_f32 v182, v58, v59
    v_cvt_pk_bf16_f32 v183, v60, v61
    v_mfma_f32_32x32x4_2b_bf16 v[30:61], v[210:211], v[166:167], v[94:125] cbsz:1 abid:0
    s_setprio 0
    v_exp_f32 v62, v62
    v_exp_f32 v63, v63
    v_exp_f32 v64, v64
    v_exp_f32 v65, v65
    v_cvt_pk_bf16_f32 v168, v62, v63
    v_cvt_pk_bf16_f32 v169, v64, v65
    v_exp_f32 v66, v66
    v_exp_f32 v67, v67
    v_exp_f32 v68, v68
    v_exp_f32 v69, v69
    v_cvt_pk_bf16_f32 v170, v66, v67
    v_cvt_pk_bf16_f32 v171, v68, v69
    v_mfma_f32_32x32x16_bf16 v[142:157], v[192:195], v[180:183], v[142:157]
    ds_read_b128 v[192:195], v21 offset:18144
    v_exp_f32 v70, v70
    v_exp_f32 v71, v71
    v_exp_f32 v72, v72
    v_exp_f32 v73, v73
    v_cvt_pk_bf16_f32 v172, v70, v71
    v_cvt_pk_bf16_f32 v173, v72, v73
    s_waitcnt lgkmcnt(1)
    v_mfma_f32_32x32x16_bf16 v[126:141], v[188:191], v[168:171], v[126:141]
    v_exp_f32 v74, v74
    v_exp_f32 v75, v75
    v_exp_f32 v76, v76
    v_exp_f32 v77, v77
    v_cvt_pk_bf16_f32 v174, v74, v75
    v_cvt_pk_bf16_f32 v175, v76, v77
    v_mfma_f32_32x32x16_bf16 v[30:45], v[184:187], v[158:161], v[30:45]
    v_exp_f32 v78, v78
    v_exp_f32 v79, v79
    v_exp_f32 v80, v80
    v_exp_f32 v81, v81
    v_cvt_pk_bf16_f32 v176, v78, v79
    v_cvt_pk_bf16_f32 v177, v80, v81
    s_waitcnt lgkmcnt(0)
    v_mfma_f32_32x32x16_bf16 v[126:141], v[192:195], v[172:175], v[126:141]
    v_exp_f32 v82, v82
    v_exp_f32 v83, v83
    v_exp_f32 v84, v84
    v_exp_f32 v85, v85
    v_cvt_pk_bf16_f32 v178, v82, v83
    v_cvt_pk_bf16_f32 v179, v84, v85
    v_mfma_f32_32x32x16_bf16 v[46:61], v[184:187], v[162:165], v[46:61]
    ds_read_b128 v[184:187], v20 offset:15360
    v_exp_f32 v86, v86
    v_exp_f32 v87, v87
    v_exp_f32 v88, v88
    v_exp_f32 v89, v89
    v_cvt_pk_bf16_f32 v180, v86, v87
    v_cvt_pk_bf16_f32 v181, v88, v89
    v_mfma_f32_32x32x16_bf16 v[142:157], v[188:191], v[176:179], v[142:157]
    ds_read_b128 v[188:191], v21 offset:18816
    v_exp_f32 v90, v90
    v_exp_f32 v91, v91
    v_exp_f32 v92, v92
    v_exp_f32 v93, v93
    v_cvt_pk_bf16_f32 v182, v90, v91
    v_cvt_pk_bf16_f32 v183, v92, v93
    s_waitcnt vmcnt(0)
    s_barrier
    s_cmp_lg_u32 s20, 0
    s_cbranch_scc1 L_sequ_w0_35
    s_lshl_b32 s50, s26, 2
    s_add_u32 s50, s50, 22544384
    v_mov_b32 v11, 0
    v_mov_b32 v12, s3
    s_mov_b64 exec, 1
    buffer_store_dword v12, v11, s[4:7], s50 offen sc1
    s_mov_b64 exec, -1
L_sequ_w0_35:
    v_mfma_f32_32x32x4_2b_bf16 v[62:93], v[210:211], v[166:167], v[94:125] cbsz:1 abid:1
    s_setprio 3
    s_cmp_lg_u32 s20, 0
    s_cbranch_scc1 L_sequ_w0_36
    s_lshl_b32 s50, s21, 7
    s_lshl_b32 s51, s80, 7
    s_add_u32 s51, s51, 2048
    v_lshl_add_u32 v5, v1, 11, s51
    v_writelane_b32 v5, s50, 0
    s_mov_b32 s50, 22545408
    s_mov_b64 exec, 7
    buffer_load_dword v246, v5, s[4:7], s50 offen sc1
    s_mov_b64 exec, -1
L_sequ_w0_36:
    v_exp_f32 v30, v30
    v_exp_f32 v31, v31
    v_exp_f32 v32, v32
    v_exp_f32 v33, v33
    v_cvt_pk_bf16_f32 v168, v30, v31
    v_cvt_pk_bf16_f32 v169, v32, v33
    v_exp_f32 v34, v34
    v_exp_f32 v35, v35
    v_exp_f32 v36, v36
    v_exp_f32 v37, v37
    v_cvt_pk_bf16_f32 v170, v34, v35
    v_cvt_pk_bf16_f32 v171, v36, v37
    v_mfma_f32_32x32x16_bf16 v[142:157], v[192:195], v[180:183], v[142:157]
    ds_read_b128 v[192:195], v21 offset:19488
    v_exp_f32 v38, v38
    v_exp_f32 v39, v39
    v_exp_f32 v40, v40
    v_exp_f32 v41, v41
    v_cvt_pk_bf16_f32 v172, v38, v39
    v_cvt_pk_bf16_f32 v173, v40, v41
    s_waitcnt lgkmcnt(1)
    v_mfma_f32_32x32x16_bf16 v[126:141], v[188:191], v[168:171], v[126:141]
    v_exp_f32 v42, v42
    v_exp_f32 v43, v43
    v_exp_f32 v44, v44
    v_exp_f32 v45, v45
    v_cvt_pk_bf16_f32 v174, v42, v43
    v_cvt_pk_bf16_f32 v175, v44, v45
    v_mfma_f32_32x32x16_bf16 v[62:77], v[184:187], v[158:161], v[62:77]
    v_exp_f32 v46, v46
    v_exp_f32 v47, v47
    v_exp_f32 v48, v48
    v_exp_f32 v49, v49
    v_cvt_pk_bf16_f32 v176, v46, v47
    v_cvt_pk_bf16_f32 v177, v48, v49
    s_waitcnt lgkmcnt(0)
    v_mfma_f32_32x32x16_bf16 v[126:141], v[192:195], v[172:175], v[126:141]
    v_exp_f32 v50, v50
    v_exp_f32 v51, v51
    v_exp_f32 v52, v52
    v_exp_f32 v53, v53
    v_cvt_pk_bf16_f32 v178, v50, v51
    v_cvt_pk_bf16_f32 v179, v52, v53
    v_mfma_f32_32x32x16_bf16 v[78:93], v[184:187], v[162:165], v[78:93]
    ds_read_b128 v[184:187], v20 offset:16384
    v_exp_f32 v54, v54
    v_exp_f32 v55, v55
    v_exp_f32 v56, v56
    v_exp_f32 v57, v57
    v_cvt_pk_bf16_f32 v180, v54, v55
    v_cvt_pk_bf16_f32 v181, v56, v57
    v_mfma_f32_32x32x16_bf16 v[142:157], v[188:191], v[176:179], v[142:157]
    ds_read_b128 v[188:191], v21 offset:20160
    v_exp_f32 v58, v58
    v_exp_f32 v59, v59
    v_exp_f32 v60, v60
    v_exp_f32 v61, v61
    v_cvt_pk_bf16_f32 v182, v58, v59
    v_cvt_pk_bf16_f32 v183, v60, v61
    v_mfma_f32_32x32x4_2b_bf16 v[30:61], v[212:213], v[166:167], v[94:125] cbsz:1 abid:0
    v_exp_f32 v62, v62
    v_exp_f32 v63, v63
    v_exp_f32 v64, v64
    v_exp_f32 v65, v65
    v_cvt_pk_bf16_f32 v168, v62, v63
    v_cvt_pk_bf16_f32 v169, v64, v65
    v_exp_f32 v66, v66
    v_exp_f32 v67, v67
    v_exp_f32 v68, v68
    v_exp_f32 v69, v69
    v_cvt_pk_bf16_f32 v170, v66, v67
    v_cvt_pk_bf16_f32 v171, v68, v69
    v_mfma_f32_32x32x16_bf16 v[142:157], v[192:195], v[180:183], v[142:157]
    ds_read_b128 v[192:195], v21 offset:20832
    v_exp_f32 v70, v70
    v_exp_f32 v71, v71
    v_exp_f32 v72, v72
    v_exp_f32 v73, v73
    v_cvt_pk_bf16_f32 v172, v70, v71
    v_cvt_pk_bf16_f32 v173, v72, v73
    s_waitcnt lgkmcnt(1)
    v_mfma_f32_32x32x16_bf16 v[126:141], v[188:191], v[168:171], v[126:141]
    v_exp_f32 v74, v74
    v_exp_f32 v75, v75
    v_exp_f32 v76, v76
    v_exp_f32 v77, v77
    v_cvt_pk_bf16_f32 v174, v74, v75
    v_cvt_pk_bf16_f32 v175, v76, v77
    v_mfma_f32_32x32x16_bf16 v[30:45], v[184:187], v[158:161], v[30:45]
    v_exp_f32 v78, v78
    v_exp_f32 v79, v79
    v_exp_f32 v80, v80
    v_exp_f32 v81, v81
    v_cvt_pk_bf16_f32 v176, v78, v79
    v_cvt_pk_bf16_f32 v177, v80, v81
    s_waitcnt lgkmcnt(0)
    v_mfma_f32_32x32x16_bf16 v[126:141], v[192:195], v[172:175], v[126:141]
    v_exp_f32 v82, v82
    v_exp_f32 v83, v83
    v_exp_f32 v84, v84
    v_exp_f32 v85, v85
    v_cvt_pk_bf16_f32 v178, v82, v83
    v_cvt_pk_bf16_f32 v179, v84, v85
    v_mfma_f32_32x32x16_bf16 v[46:61], v[184:187], v[162:165], v[46:61]
    ds_read_b128 v[184:187], v20 offset:17408
    v_exp_f32 v86, v86
    v_exp_f32 v87, v87
    v_exp_f32 v88, v88
    v_exp_f32 v89, v89
    v_cvt_pk_bf16_f32 v180, v86, v87
    v_cvt_pk_bf16_f32 v181, v88, v89
    v_mfma_f32_32x32x16_bf16 v[142:157], v[188:191], v[176:179], v[142:157]
    ds_read_b128 v[188:191], v21 offset:21504
    v_exp_f32 v90, v90
    v_exp_f32 v91, v91
    v_exp_f32 v92, v92
    v_exp_f32 v93, v93
    v_cvt_pk_bf16_f32 v182, v90, v91
    v_cvt_pk_bf16_f32 v183, v92, v93
    v_mfma_f32_32x32x4_2b_bf16 v[62:93], v[212:213], v[166:167], v[94:125] cbsz:1 abid:1
    s_setprio 2
    buffer_load_dword v246, v25, s[4:7], 0 offen offset:0 sc1
    v_exp_f32 v30, v30
    v_exp_f32 v31, v31
    v_exp_f32 v32, v32
    v_exp_f32 v33, v33
    v_cvt_pk_bf16_f32 v168, v30, v31
    v_cvt_pk_bf16_f32 v169, v32, v33
    v_exp_f32 v34, v34
    v_exp_f32 v35, v35
    v_exp_f32 v36, v36
    v_exp_f32 v37, v37
    v_cvt_pk_bf16_f32 v170, v34, v35
    v_cvt_pk_bf16_f32 v171, v36, v37
    v_mfma_f32_32x32x16_bf16 v[142:157], v[192:195], v[180:183], v[142:157]
    ds_read_b128 v[192:195], v21 offset:22176
    v_exp_f32 v38, v38
    v_exp_f32 v39, v39
    v_exp_f32 v40, v40
    v_exp_f32 v41, v41
    v_cvt_pk_bf16_f32 v172, v38, v39
    v_cvt_pk_bf16_f32 v173, v40, v41
    s_waitcnt lgkmcnt(1)
    v_mfma_f32_32x32x16_bf16 v[126:141], v[188:191], v[168:171], v[126:141]
    buffer_load_dword v246, v24, s[4:7], 0 offen offset:0 sc1
    v_exp_f32 v42, v42
    v_exp_f32 v43, v43
    v_exp_f32 v44, v44
    v_exp_f32 v45, v45
    v_cvt_pk_bf16_f32 v174, v42, v43
    v_cvt_pk_bf16_f32 v175, v44, v45
    v_mfma_f32_32x32x16_bf16 v[62:77], v[184:187], v[158:161], v[62:77]
    s_mul_i32 s74, s27, 7
    s_add_u32 s74, s74, s20
    s_sub_u32 s74, s74, 1
    v_exp_f32 v46, v46
    v_exp_f32 v47, v47
    v_exp_f32 v48, v48
    v_exp_f32 v49, v49
    v_cvt_pk_bf16_f32 v176, v46, v47
    v_cvt_pk_bf16_f32 v177, v48, v49
    s_waitcnt lgkmcnt(0)
    v_mfma_f32_32x32x16_bf16 v[126:141], v[192:195], v[172:175], v[126:141]
    s_cmp_eq_u32 s74, 111
    s_cselect_b32 s74, 107, s74
    s_max_i32 s74, s74, 0
    v_exp_f32 v50, v50
    v_exp_f32 v51, v51
    v_exp_f32 v52, v52
    v_exp_f32 v53, v53
    v_cvt_pk_bf16_f32 v178, v50, v51
    v_cvt_pk_bf16_f32 v179, v52, v53
    v_mfma_f32_32x32x16_bf16 v[78:93], v[184:187], v[162:165], v[78:93]
    ds_read_b128 v[184:187], v20 offset:18432
    v_exp_f32 v54, v54
    v_exp_f32 v55, v55
    v_exp_f32 v56, v56
    v_exp_f32 v57, v57
    v_cvt_pk_bf16_f32 v180, v54, v55
    v_cvt_pk_bf16_f32 v181, v56, v57
    v_mfma_f32_32x32x16_bf16 v[142:157], v[188:191], v[176:179], v[142:157]
    ds_read_b128 v[188:191], v21 offset:22848
    v_exp_f32 v58, v58
    v_exp_f32 v59, v59
    v_exp_f32 v60, v60
    v_exp_f32 v61, v61
    v_cvt_pk_bf16_f32 v182, v58, v59
    v_cvt_pk_bf16_f32 v183, v60, v61
    v_mfma_f32_32x32x4_2b_bf16 v[30:61], v[214:215], v[166:167], v[94:125] cbsz:1 abid:0
    s_setprio 1
    s_lshl_b32 s75, s74, 5
    s_lshl_b32 s74, s74, 6
    s_add_u32 s74, s74, 22282240
    v_exp_f32 v62, v62
    v_exp_f32 v63, v63
    v_exp_f32 v64, v64
    v_exp_f32 v65, v65
    v_cvt_pk_bf16_f32 v168, v62, v63
    v_cvt_pk_bf16_f32 v169, v64, v65
    v_exp_f32 v66, v66
    v_exp_f32 v67, v67
    v_exp_f32 v68, v68
    v_exp_f32 v69, v69
    v_cvt_pk_bf16_f32 v170, v66, v67
    v_cvt_pk_bf16_f32 v171, v68, v69
    v_mfma_f32_32x32x16_bf16 v[142:157], v[192:195], v[180:183], v[142:157]
    ds_read_b128 v[192:195], v21 offset:23520
    v_exp_f32 v70, v70
    v_exp_f32 v71, v71
    v_exp_f32 v72, v72
    v_exp_f32 v73, v73
    v_cvt_pk_bf16_f32 v172, v70, v71
    v_cvt_pk_bf16_f32 v173, v72, v73
    s_waitcnt lgkmcnt(1)
    v_mfma_f32_32x32x16_bf16 v[126:141], v[188:191], v[168:171], v[126:141]
    s_mov_b32 s16, s38
    s_mov_b32 s17, s39
    s_mov_b32 s18, 3456
    s_mov_b32 s19, 0x00020000
    v_exp_f32 v74, v74
    v_exp_f32 v75, v75
    v_exp_f32 v76, v76
    v_exp_f32 v77, v77
    v_cvt_pk_bf16_f32 v174, v74, v75
    v_cvt_pk_bf16_f32 v175, v76, v77
    v_mfma_f32_32x32x16_bf16 v[30:45], v[184:187], v[158:161], v[30:45]
    v_mul_u32_u24 v236, 7168, v4
    v_lshl_add_u32 v236, v3, 2, v236
    v_lshlrev_b32 v237, 1, v3
    v_exp_f32 v78, v78
    v_exp_f32 v79, v79
    v_exp_f32 v80, v80
    v_exp_f32 v81, v81
    v_cvt_pk_bf16_f32 v176, v78, v79
    v_cvt_pk_bf16_f32 v177, v80, v81
    s_waitcnt lgkmcnt(0)
    v_mfma_f32_32x32x16_bf16 v[126:141], v[192:195], v[172:175], v[126:141]
    buffer_load_short_d16_hi v0, v237, s[16:19], s75 offen
    v_exp_f32 v82, v82
    v_exp_f32 v83, v83
    v_exp_f32 v84, v84
    v_exp_f32 v85, v85
    v_cvt_pk_bf16_f32 v178, v82, v83
    v_cvt_pk_bf16_f32 v179, v84, v85
    v_mfma_f32_32x32x16_bf16 v[46:61], v[184:187], v[162:165], v[46:61]
    ds_read_b128 v[184:187], v20 offset:19456
    v_exp_f32 v86, v86
    v_exp_f32 v87, v87
    v_exp_f32 v88, v88
    v_exp_f32 v89, v89
    v_cvt_pk_bf16_f32 v180, v86, v87
    v_cvt_pk_bf16_f32 v181, v88, v89
    v_mfma_f32_32x32x16_bf16 v[142:157], v[188:191], v[176:179], v[142:157]
    ds_read_b128 v[188:191], v21 offset:24192
    v_exp_f32 v90, v90
    v_exp_f32 v91, v91
    v_exp_f32 v92, v92
    v_exp_f32 v93, v93
    v_cvt_pk_bf16_f32 v182, v90, v91
    v_cvt_pk_bf16_f32 v183, v92, v93
    v_mfma_f32_32x32x4_2b_bf16 v[62:93], v[214:215], v[166:167], v[94:125] cbsz:1 abid:1
    s_cmp_lg_u32 s20, 0
    s_cbranch_scc1 L_sequ_w0_37
    s_mov_b32 s50, 22544384
    buffer_load_dwordx4 v[228:231], v2, s[4:7], s50 offen sc1
L_sequ_w0_37:
    v_exp_f32 v30, v30
    v_exp_f32 v31, v31
    v_exp_f32 v32, v32
    v_exp_f32 v33, v33
    v_cvt_pk_bf16_f32 v168, v30, v31
    v_cvt_pk_bf16_f32 v169, v32, v33
    v_exp_f32 v34, v34
    v_exp_f32 v35, v35
    v_exp_f32 v36, v36
    v_exp_f32 v37, v37
    v_cvt_pk_bf16_f32 v170, v34, v35
    v_cvt_pk_bf16_f32 v171, v36, v37
    v_mfma_f32_32x32x16_bf16 v[142:157], v[192:195], v[180:183], v[142:157]
    ds_read_b128 v[192:195], v21 offset:24864
    v_exp_f32 v38, v38
    v_exp_f32 v39, v39
    v_exp_f32 v40, v40
    v_exp_f32 v41, v41
    v_cvt_pk_bf16_f32 v172, v38, v39
    v_cvt_pk_bf16_f32 v173, v40, v41
    s_waitcnt lgkmcnt(1)
    v_mfma_f32_32x32x16_bf16 v[126:141], v[188:191], v[168:171], v[126:141]
    s_lshl_b32 s66, s20, 10
    s_mul_i32 s67, s27, 143360
    s_add_u32 s67, s67, 16777216
    v_exp_f32 v42, v42
    v_exp_f32 v43, v43
    v_exp_f32 v44, v44
    v_exp_f32 v45, v45
    v_cvt_pk_bf16_f32 v174, v42, v43
    v_cvt_pk_bf16_f32 v175, v44, v45
    v_mfma_f32_32x32x16_bf16 v[62:77], v[184:187], v[158:161], v[62:77]
    v_exp_f32 v46, v46
    v_exp_f32 v47, v47
    v_exp_f32 v48, v48
    v_exp_f32 v49, v49
    v_cvt_pk_bf16_f32 v176, v46, v47
    v_cvt_pk_bf16_f32 v177, v48, v49
    s_waitcnt lgkmcnt(0)
    v_mfma_f32_32x32x16_bf16 v[126:141], v[192:195], v[172:175], v[126:141]
    v_exp_f32 v50, v50
    v_exp_f32 v51, v51
    v_exp_f32 v52, v52
    v_exp_f32 v53, v53
    v_cvt_pk_bf16_f32 v178, v50, v51
    v_cvt_pk_bf16_f32 v179, v52, v53
    v_mfma_f32_32x32x16_bf16 v[78:93], v[184:187], v[162:165], v[78:93]
    ds_read_b128 v[184:187], v20 offset:20480
    v_exp_f32 v54, v54
    v_exp_f32 v55, v55
    v_exp_f32 v56, v56
    v_exp_f32 v57, v57
    v_cvt_pk_bf16_f32 v180, v54, v55
    v_cvt_pk_bf16_f32 v181, v56, v57
    v_mfma_f32_32x32x16_bf16 v[142:157], v[188:191], v[176:179], v[142:157]
    ds_read_b128 v[188:191], v21 offset:25536
    v_exp_f32 v58, v58
    v_exp_f32 v59, v59
    v_exp_f32 v60, v60
    v_exp_f32 v61, v61
    v_cvt_pk_bf16_f32 v182, v58, v59
    v_cvt_pk_bf16_f32 v183, v60, v61
    v_mfma_f32_32x32x4_2b_bf16 v[30:61], v[216:217], v[166:167], v[94:125] cbsz:1 abid:0
    s_setprio 0
    s_mul_i32 s50, s24, 43008
    s_add_u32 s50, s50, 65536
    v_add_u32 v26, s50, v2
    v_exp_f32 v62, v62
    v_exp_f32 v63, v63
    v_exp_f32 v64, v64
    v_exp_f32 v65, v65
    v_cvt_pk_bf16_f32 v168, v62, v63
    v_cvt_pk_bf16_f32 v169, v64, v65
    v_exp_f32 v66, v66
    v_exp_f32 v67, v67
    v_exp_f32 v68, v68
    v_exp_f32 v69, v69
    v_cvt_pk_bf16_f32 v170, v66, v67
    v_cvt_pk_bf16_f32 v171, v68, v69
    v_mfma_f32_32x32x16_bf16 v[142:157], v[192:195], v[180:183], v[142:157]
    ds_read_b128 v[192:195], v21 offset:26208
    v_exp_f32 v70, v70
    v_exp_f32 v71, v71
    v_exp_f32 v72, v72
    v_exp_f32 v73, v73
    v_cvt_pk_bf16_f32 v172, v70, v71
    v_cvt_pk_bf16_f32 v173, v72, v73
    s_waitcnt lgkmcnt(1)
    v_mfma_f32_32x32x16_bf16 v[126:141], v[188:191], v[168:171], v[126:141]
    s_mul_i32 s50, s23, 3072
    s_add_u32 s50, s50, 24576
    v_add_u32 v27, s50, v26
    v_exp_f32 v74, v74
    v_exp_f32 v75, v75
    v_exp_f32 v76, v76
    v_exp_f32 v77, v77
    v_cvt_pk_bf16_f32 v174, v74, v75
    v_cvt_pk_bf16_f32 v175, v76, v77
    v_mfma_f32_32x32x16_bf16 v[30:45], v[184:187], v[158:161], v[30:45]
    s_mul_i32 s50, s24, 86016
    s_sub_u32 s50, 43008, s50
    v_add_u32 v28, s50, v27
    v_exp_f32 v78, v78
    v_exp_f32 v79, v79
    v_exp_f32 v80, v80
    v_exp_f32 v81, v81
    v_cvt_pk_bf16_f32 v176, v78, v79
    v_cvt_pk_bf16_f32 v177, v80, v81
    s_waitcnt lgkmcnt(0)
    v_mfma_f32_32x32x16_bf16 v[126:141], v[192:195], v[172:175], v[126:141]
    v_exp_f32 v82, v82
    v_exp_f32 v83, v83
    v_exp_f32 v84, v84
    v_exp_f32 v85, v85
    v_cvt_pk_bf16_f32 v178, v82, v83
    v_cvt_pk_bf16_f32 v179, v84, v85
    v_mfma_f32_32x32x16_bf16 v[46:61], v[184:187], v[162:165], v[46:61]
    ds_read_b128 v[184:187], v20 offset:21504
    v_exp_f32 v86, v86
    v_exp_f32 v87, v87
    v_exp_f32 v88, v88
    v_exp_f32 v89, v89
    v_cvt_pk_bf16_f32 v180, v86, v87
    v_cvt_pk_bf16_f32 v181, v88, v89
    v_mfma_f32_32x32x16_bf16 v[142:157], v[188:191], v[176:179], v[142:157]
    ds_read_b128 v[188:191], v21 offset:26880
    v_exp_f32 v90, v90
    v_exp_f32 v91, v91
    v_exp_f32 v92, v92
    v_exp_f32 v93, v93
    v_cvt_pk_bf16_f32 v182, v90, v91
    v_cvt_pk_bf16_f32 v183, v92, v93
    s_cmp_lg_u32 s20, 0
    s_cbranch_scc1 L_sequ_w0_38
    s_waitcnt vmcnt(0)
    v_xor_b32 v228, s34, v228
    v_xor_b32 v229, s34, v229
    v_xor_b32 v230, s34, v230
    v_xor_b32 v231, s34, v231
    v_or3_b32 v228, v228, v229, v230
    v_or_b32 v228, v228, v231
    v_cmp_lt_u32 vcc, 7, v228
    s_mov_b32 s50, 22544384
    s_cbranch_vccz L_sequ_rpok_39
    s_mov_b32 s78, 0
L_sequ_poll_40:
    buffer_load_dwordx4 v[228:231], v2, s[4:7], s50 offen sc1
    s_add_u32 s78, s78, 1
    s_waitcnt vmcnt(0)
    v_xor_b32 v228, s34, v228
    v_xor_b32 v229, s34, v229
    v_xor_b32 v230, s34, v230
    v_xor_b32 v231, s34, v231
    v_or3_b32 v228, v228, v229, v230
    v_or_b32 v228, v228, v231
    v_cmp_lt_u32 vcc, 7, v228
    s_cmp_gt_u32 s78, 0x40000
    s_cbranch_scc1 L_sequ_polld_41
    s_cbranch_vccnz L_sequ_poll_40
L_sequ_polld_41:
    s_mov_b64 exec, -1
L_sequ_rpok_39:
L_sequ_w0_38:
    s_waitcnt vmcnt(3)
    s_barrier
    v_mfma_f32_32x32x4_2b_bf16 v[62:93], v[216:217], v[166:167], v[94:125] cbsz:1 abid:1
    s_setprio 3
    s_add_u32 s64, s61, 16777216
    buffer_load_dword v246, v245, s[4:7], s64 offen sc1
    v_exp_f32 v30, v30
    v_exp_f32 v31, v31
    v_exp_f32 v32, v32
    v_exp_f32 v33, v33
    v_cvt_pk_bf16_f32 v168, v30, v31
    v_cvt_pk_bf16_f32 v169, v32, v33
    v_exp_f32 v34, v34
    v_exp_f32 v35, v35
    v_exp_f32 v36, v36
    v_exp_f32 v37, v37
    v_cvt_pk_bf16_f32 v170, v34, v35
    v_cvt_pk_bf16_f32 v171, v36, v37
    v_mfma_f32_32x32x16_bf16 v[142:157], v[192:195], v[180:183], v[142:157]
    ds_read_b128 v[192:195], v21 offset:27552
    v_exp_f32 v38, v38
    v_exp_f32 v39, v39
    v_exp_f32 v40, v40
    v_exp_f32 v41, v41
    v_cvt_pk_bf16_f32 v172, v38, v39
    v_cvt_pk_bf16_f32 v173, v40, v41
    s_waitcnt lgkmcnt(1)
    v_mfma_f32_32x32x16_bf16 v[126:141], v[188:191], v[168:171], v[126:141]
    s_add_u32 m0, s53, 0
    s_add_u32 s65, m0, s57
    v_exp_f32 v42, v42
    v_exp_f32 v43, v43
    v_exp_f32 v44, v44
    v_exp_f32 v45, v45
    v_cvt_pk_bf16_f32 v174, v42, v43
    v_cvt_pk_bf16_f32 v175, v44, v45
    v_mfma_f32_32x32x16_bf16 v[62:77], v[184:187], v[158:161], v[62:77]
    buffer_load_dwordx4 v2, s[4:7], s65 offen offset:0 sc1 lds
    v_exp_f32 v46, v46
    v_exp_f32 v47, v47
    v_exp_f32 v48, v48
    v_exp_f32 v49, v49
    v_cvt_pk_bf16_f32 v176, v46, v47
    v_cvt_pk_bf16_f32 v177, v48, v49
    s_waitcnt lgkmcnt(0)
    v_mfma_f32_32x32x16_bf16 v[126:141], v[192:195], v[172:175], v[126:141]
    buffer_load_dwordx4 v2, s[4:7], s65 offen offset:1024 sc1 lds
    v_exp_f32 v50, v50
    v_exp_f32 v51, v51
    v_exp_f32 v52, v52
    v_exp_f32 v53, v53
    v_cvt_pk_bf16_f32 v178, v50, v51
    v_cvt_pk_bf16_f32 v179, v52, v53
    v_mfma_f32_32x32x16_bf16 v[78:93], v[184:187], v[162:165], v[78:93]
    ds_read_b128 v[184:187], v20 offset:22528
    v_exp_f32 v54, v54
    v_exp_f32 v55, v55
    v_exp_f32 v56, v56
    v_exp_f32 v57, v57
    v_cvt_pk_bf16_f32 v180, v54, v55
    v_cvt_pk_bf16_f32 v181, v56, v57
    v_mfma_f32_32x32x16_bf16 v[142:157], v[188:191], v[176:179], v[142:157]
    ds_read_b128 v[188:191], v21 offset:28224
    v_exp_f32 v58, v58
    v_exp_f32 v59, v59
    v_exp_f32 v60, v60
    v_exp_f32 v61, v61
    v_cvt_pk_bf16_f32 v182, v58, v59
    v_cvt_pk_bf16_f32 v183, v60, v61
    v_mfma_f32_32x32x4_2b_bf16 v[30:61], v[218:219], v[166:167], v[94:125] cbsz:1 abid:0
    buffer_load_dwordx4 v2, s[4:7], s65 offen offset:2048 sc1 lds
    v_exp_f32 v62, v62
    v_exp_f32 v63, v63
    v_exp_f32 v64, v64
    v_exp_f32 v65, v65
    v_cvt_pk_bf16_f32 v168, v62, v63
    v_cvt_pk_bf16_f32 v169, v64, v65
    v_exp_f32 v66, v66
    v_exp_f32 v67, v67
    v_exp_f32 v68, v68
    v_exp_f32 v69, v69
    v_cvt_pk_bf16_f32 v170, v66, v67
    v_cvt_pk_bf16_f32 v171, v68, v69
    v_mfma_f32_32x32x16_bf16 v[142:157], v[192:195], v[180:183], v[142:157]
    ds_read_b128 v[192:195], v21 offset:28896
    v_exp_f32 v70, v70
    v_exp_f32 v71, v71
    v_exp_f32 v72, v72
    v_exp_f32 v73, v73
    v_cvt_pk_bf16_f32 v172, v70, v71
    v_cvt_pk_bf16_f32 v173, v72, v73
    s_waitcnt lgkmcnt(1)
    v_mfma_f32_32x32x16_bf16 v[126:141], v[188:191], v[168:171], v[126:141]
    buffer_load_dwordx4 v2, s[4:7], s65 offen offset:3072 sc1 lds
    v_exp_f32 v74, v74
    v_exp_f32 v75, v75
    v_exp_f32 v76, v76
    v_exp_f32 v77, v77
    v_cvt_pk_bf16_f32 v174, v74, v75
    v_cvt_pk_bf16_f32 v175, v76, v77
    v_mfma_f32_32x32x16_bf16 v[30:45], v[184:187], v[158:161], v[30:45]
    s_add_u32 m0, s30, 16384
    s_add_u32 s65, m0, s57
    v_exp_f32 v78, v78
    v_exp_f32 v79, v79
    v_exp_f32 v80, v80
    v_exp_f32 v81, v81
    v_cvt_pk_bf16_f32 v176, v78, v79
    v_cvt_pk_bf16_f32 v177, v80, v81
    s_waitcnt lgkmcnt(0)
    v_mfma_f32_32x32x16_bf16 v[126:141], v[192:195], v[172:175], v[126:141]
    buffer_load_dwordx4 v2, s[4:7], s65 offen offset:0 sc1 lds
    v_exp_f32 v82, v82
    v_exp_f32 v83, v83
    v_exp_f32 v84, v84
    v_exp_f32 v85, v85
    v_cvt_pk_bf16_f32 v178, v82, v83
    v_cvt_pk_bf16_f32 v179, v84, v85
    v_mfma_f32_32x32x16_bf16 v[46:61], v[184:187], v[162:165], v[46:61]
    ds_read_b128 v[184:187], v20 offset:23552
    v_exp_f32 v86, v86
    v_exp_f32 v87, v87
    v_exp_f32 v88, v88
    v_exp_f32 v89, v89
    v_cvt_pk_bf16_f32 v180, v86, v87
    v_cvt_pk_bf16_f32 v181, v88, v89
    v_mfma_f32_32x32x16_bf16 v[142:157], v[188:191], v[176:179], v[142:157]
    ds_read_b128 v[188:191], v21 offset:29568
    v_exp_f32 v90, v90
    v_exp_f32 v91, v91
    v_exp_f32 v92, v92
    v_exp_f32 v93, v93
    v_cvt_pk_bf16_f32 v182, v90, v91
    v_cvt_pk_bf16_f32 v183, v92, v93
    v_mfma_f32_32x32x4_2b_bf16 v[62:93], v[218:219], v[166:167], v[94:125] cbsz:1 abid:1
    s_setprio 2
    s_add_u32 s64, s61, 17301504
    buffer_load_dword v246, v245, s[4:7], s64 offen sc1
    v_exp_f32 v30, v30
    v_exp_f32 v31, v31
    v_exp_f32 v32, v32
    v_exp_f32 v33, v33
    v_cvt_pk_bf16_f32 v168, v30, v31
    v_cvt_pk_bf16_f32 v169, v32, v33
    v_exp_f32 v34, v34
    v_exp_f32 v35, v35
    v_exp_f32 v36, v36
    v_exp_f32 v37, v37
    v_cvt_pk_bf16_f32 v170, v34, v35
    v_cvt_pk_bf16_f32 v171, v36, v37
    v_mfma_f32_32x32x16_bf16 v[142:157], v[192:195], v[180:183], v[142:157]
    ds_read_b128 v[192:195], v21 offset:30240
    v_exp_f32 v38, v38
    v_exp_f32 v39, v39
    v_exp_f32 v40, v40
    v_exp_f32 v41, v41
    v_cvt_pk_bf16_f32 v172, v38, v39
    v_cvt_pk_bf16_f32 v173, v40, v41
    s_waitcnt lgkmcnt(1)
    v_mfma_f32_32x32x16_bf16 v[126:141], v[188:191], v[168:171], v[126:141]
    s_add_u32 m0, s56, 0
    s_add_u32 s65, m0, s58
    v_exp_f32 v42, v42
    v_exp_f32 v43, v43
    v_exp_f32 v44, v44
    v_exp_f32 v45, v45
    v_cvt_pk_bf16_f32 v174, v42, v43
    v_cvt_pk_bf16_f32 v175, v44, v45
    v_mfma_f32_32x32x16_bf16 v[62:77], v[184:187], v[158:161], v[62:77]
    buffer_load_dwordx4 v2, s[4:7], s65 offen offset:0 sc1 lds
    v_exp_f32 v46, v46
    v_exp_f32 v47, v47
    v_exp_f32 v48, v48
    v_exp_f32 v49, v49
    v_cvt_pk_bf16_f32 v176, v46, v47
    v_cvt_pk_bf16_f32 v177, v48, v49
    s_waitcnt lgkmcnt(0)
    v_mfma_f32_32x32x16_bf16 v[126:141], v[192:195], v[172:175], v[126:141]
    buffer_load_dwordx4 v2, s[4:7], s65 offen offset:1024 sc1 lds
    v_exp_f32 v50, v50
    v_exp_f32 v51, v51
    v_exp_f32 v52, v52
    v_exp_f32 v53, v53
    v_cvt_pk_bf16_f32 v178, v50, v51
    v_cvt_pk_bf16_f32 v179, v52, v53
    v_mfma_f32_32x32x16_bf16 v[78:93], v[184:187], v[162:165], v[78:93]
    ds_read_b128 v[184:187], v20 offset:24576
    v_exp_f32 v54, v54
    v_exp_f32 v55, v55
    v_exp_f32 v56, v56
    v_exp_f32 v57, v57
    v_cvt_pk_bf16_f32 v180, v54, v55
    v_cvt_pk_bf16_f32 v181, v56, v57
    v_mfma_f32_32x32x16_bf16 v[142:157], v[188:191], v[176:179], v[142:157]
    ds_read_b128 v[188:191], v21 offset:30912
    v_exp_f32 v58, v58
    v_exp_f32 v59, v59
    v_exp_f32 v60, v60
    v_exp_f32 v61, v61
    v_cvt_pk_bf16_f32 v182, v58, v59
    v_cvt_pk_bf16_f32 v183, v60, v61
    v_mfma_f32_32x32x4_2b_bf16 v[30:61], v[220:221], v[166:167], v[94:125] cbsz:1 abid:0
    buffer_load_dwordx4 v2, s[4:7], s65 offen offset:2048 sc1 lds
    v_exp_f32 v62, v62
    v_exp_f32 v63, v63
    v_exp_f32 v64, v64
    v_exp_f32 v65, v65
    v_cvt_pk_bf16_f32 v168, v62, v63
    v_cvt_pk_bf16_f32 v169, v64, v65
    v_exp_f32 v66, v66
    v_exp_f32 v67, v67
    v_exp_f32 v68, v68
    v_exp_f32 v69, v69
    v_cvt_pk_bf16_f32 v170, v66, v67
    v_cvt_pk_bf16_f32 v171, v68, v69
    v_mfma_f32_32x32x16_bf16 v[142:157], v[192:195], v[180:183], v[142:157]
    ds_read_b128 v[192:195], v21 offset:31584
    v_exp_f32 v70, v70
    v_exp_f32 v71, v71
    v_exp_f32 v72, v72
    v_exp_f32 v73, v73
    v_cvt_pk_bf16_f32 v172, v70, v71
    v_cvt_pk_bf16_f32 v173, v72, v73
    s_waitcnt lgkmcnt(1)
    v_mfma_f32_32x32x16_bf16 v[126:141], v[188:191], v[168:171], v[126:141]
    buffer_load_dwordx4 v2, s[4:7], s65 offen offset:3072 sc1 lds
    v_exp_f32 v74, v74
    v_exp_f32 v75, v75
    v_exp_f32 v76, v76
    v_exp_f32 v77, v77
    v_cvt_pk_bf16_f32 v174, v74, v75
    v_cvt_pk_bf16_f32 v175, v76, v77
    v_mfma_f32_32x32x16_bf16 v[30:45], v[184:187], v[158:161], v[30:45]
    v_exp_f32 v78, v78
    v_exp_f32 v79, v79
    v_exp_f32 v80, v80
    v_exp_f32 v81, v81
    v_cvt_pk_bf16_f32 v176, v78, v79
    v_cvt_pk_bf16_f32 v177, v80, v81
    s_waitcnt lgkmcnt(0)
    v_mfma_f32_32x32x16_bf16 v[126:141], v[192:195], v[172:175], v[126:141]
    v_exp_f32 v82, v82
    v_exp_f32 v83, v83
    v_exp_f32 v84, v84
    v_exp_f32 v85, v85
    v_cvt_pk_bf16_f32 v178, v82, v83
    v_cvt_pk_bf16_f32 v179, v84, v85
    v_mfma_f32_32x32x16_bf16 v[46:61], v[184:187], v[162:165], v[46:61]
    ds_read_b128 v[184:187], v20 offset:25600
    v_exp_f32 v86, v86
    v_exp_f32 v87, v87
    v_exp_f32 v88, v88
    v_exp_f32 v89, v89
    v_cvt_pk_bf16_f32 v180, v86, v87
    v_cvt_pk_bf16_f32 v181, v88, v89
    v_mfma_f32_32x32x16_bf16 v[142:157], v[188:191], v[176:179], v[142:157]
    ds_read_b128 v[188:191], v21 offset:32256
    v_exp_f32 v90, v90
    v_exp_f32 v91, v91
    v_exp_f32 v92, v92
    v_exp_f32 v93, v93
    v_cvt_pk_bf16_f32 v182, v90, v91
    v_cvt_pk_bf16_f32 v183, v92, v93
    v_mfma_f32_32x32x4_2b_bf16 v[62:93], v[220:221], v[166:167], v[94:125] cbsz:1 abid:1
    s_setprio 1
    s_add_u32 s64, s61, 17825792
    buffer_load_dword v246, v245, s[4:7], s64 offen sc1
    v_exp_f32 v30, v30
    v_exp_f32 v31, v31
    v_exp_f32 v32, v32
    v_exp_f32 v33, v33
    v_cvt_pk_bf16_f32 v168, v30, v31
    v_cvt_pk_bf16_f32 v169, v32, v33
    v_exp_f32 v34, v34
    v_exp_f32 v35, v35
    v_exp_f32 v36, v36
    v_exp_f32 v37, v37
    v_cvt_pk_bf16_f32 v170, v34, v35
    v_cvt_pk_bf16_f32 v171, v36, v37
    v_mfma_f32_32x32x16_bf16 v[142:157], v[192:195], v[180:183], v[142:157]
    ds_read_b128 v[192:195], v21 offset:32928
    v_exp_f32 v38, v38
    v_exp_f32 v39, v39
    v_exp_f32 v40, v40
    v_exp_f32 v41, v41
    v_cvt_pk_bf16_f32 v172, v38, v39
    v_cvt_pk_bf16_f32 v173, v40, v41
    s_waitcnt lgkmcnt(1)
    v_mfma_f32_32x32x16_bf16 v[126:141], v[188:191], v[168:171], v[126:141]
    s_add_u32 m0, s54, 16384
    s_add_u32 s65, m0, s58
    v_exp_f32 v42, v42
    v_exp_f32 v43, v43
    v_exp_f32 v44, v44
    v_exp_f32 v45, v45
    v_cvt_pk_bf16_f32 v174, v42, v43
    v_cvt_pk_bf16_f32 v175, v44, v45
    v_mfma_f32_32x32x16_bf16 v[62:77], v[184:187], v[158:161], v[62:77]
    buffer_load_dwordx4 v2, s[4:7], s65 offen offset:0 sc1 lds
    v_exp_f32 v46, v46
    v_exp_f32 v47, v47
    v_exp_f32 v48, v48
    v_exp_f32 v49, v49
    v_cvt_pk_bf16_f32 v176, v46, v47
    v_cvt_pk_bf16_f32 v177, v48, v49
    s_waitcnt lgkmcnt(0)
    v_mfma_f32_32x32x16_bf16 v[126:141], v[192:195], v[172:175], v[126:141]
    buffer_load_dwordx4 v2, s[4:7], s65 offen offset:1024 sc1 lds
    v_exp_f32 v50, v50
    v_exp_f32 v51, v51
    v_exp_f32 v52, v52
    v_exp_f32 v53, v53
    v_cvt_pk_bf16_f32 v178, v50, v51
    v_cvt_pk_bf16_f32 v179, v52, v53
    v_mfma_f32_32x32x16_bf16 v[78:93], v[184:187], v[162:165], v[78:93]
    ds_read_b128 v[184:187], v20 offset:26624
    v_exp_f32 v54, v54
    v_exp_f32 v55, v55
    v_exp_f32 v56, v56
    v_exp_f32 v57, v57
    v_cvt_pk_bf16_f32 v180, v54, v55
    v_cvt_pk_bf16_f32 v181, v56, v57
    v_mfma_f32_32x32x16_bf16 v[142:157], v[188:191], v[176:179], v[142:157]
    ds_read_b128 v[188:191], v21 offset:33600
    v_exp_f32 v58, v58
    v_exp_f32 v59, v59
    v_exp_f32 v60, v60
    v_exp_f32 v61, v61
    v_cvt_pk_bf16_f32 v182, v58, v59
    v_cvt_pk_bf16_f32 v183, v60, v61
    v_mfma_f32_32x32x4_2b_bf16 v[30:61], v[222:223], v[166:167], v[94:125] cbsz:1 abid:0
    s_add_u32 m0, s59, 151552
    s_add_u32 s65, m0, s60
    v_exp_f32 v62, v62
    v_exp_f32 v63, v63
    v_exp_f32 v64, v64
    v_exp_f32 v65, v65
    v_cvt_pk_bf16_f32 v168, v62, v63
    v_cvt_pk_bf16_f32 v169, v64, v65
    v_exp_f32 v66, v66
    v_exp_f32 v67, v67
    v_exp_f32 v68, v68
    v_exp_f32 v69, v69
    v_cvt_pk_bf16_f32 v170, v66, v67
    v_cvt_pk_bf16_f32 v171, v68, v69
    v_mfma_f32_32x32x16_bf16 v[142:157], v[192:195], v[180:183], v[142:157]
    ds_read_b128 v[192:195], v21 offset:34272
    v_exp_f32 v70, v70
    v_exp_f32 v71, v71
    v_exp_f32 v72, v72
    v_exp_f32 v73, v73
    v_cvt_pk_bf16_f32 v172, v70, v71
    v_cvt_pk_bf16_f32 v173, v72, v73
    s_waitcnt lgkmcnt(1)
    v_mfma_f32_32x32x16_bf16 v[126:141], v[188:191], v[168:171], v[126:141]
    buffer_load_dwordx4 v2, s[4:7], s65 offen offset:0 sc1 lds
    v_exp_f32 v74, v74
    v_exp_f32 v75, v75
    v_exp_f32 v76, v76
    v_exp_f32 v77, v77
    v_cvt_pk_bf16_f32 v174, v74, v75
    v_cvt_pk_bf16_f32 v175, v76, v77
    v_mfma_f32_32x32x16_bf16 v[30:45], v[184:187], v[158:161], v[30:45]
    buffer_load_dwordx4 v2, s[4:7], s65 offen offset:1024 sc1 lds
    v_exp_f32 v78, v78
    v_exp_f32 v79, v79
    v_exp_f32 v80, v80
    v_exp_f32 v81, v81
    v_cvt_pk_bf16_f32 v176, v78, v79
    v_cvt_pk_bf16_f32 v177, v80, v81
    s_waitcnt lgkmcnt(0)
    v_mfma_f32_32x32x16_bf16 v[126:141], v[192:195], v[172:175], v[126:141]
    v_exp_f32 v82, v82
    v_exp_f32 v83, v83
    v_exp_f32 v84, v84
    v_exp_f32 v85, v85
    v_cvt_pk_bf16_f32 v178, v82, v83
    v_cvt_pk_bf16_f32 v179, v84, v85
    v_mfma_f32_32x32x16_bf16 v[46:61], v[184:187], v[162:165], v[46:61]
    ds_read_b128 v[184:187], v20 offset:27648
    v_exp_f32 v86, v86
    v_exp_f32 v87, v87
    v_exp_f32 v88, v88
    v_exp_f32 v89, v89
    v_cvt_pk_bf16_f32 v180, v86, v87
    v_cvt_pk_bf16_f32 v181, v88, v89
    v_mfma_f32_32x32x16_bf16 v[142:157], v[188:191], v[176:179], v[142:157]
    ds_read_b128 v[188:191], v21 offset:34944
    v_exp_f32 v90, v90
    v_exp_f32 v91, v91
    v_exp_f32 v92, v92
    v_exp_f32 v93, v93
    v_cvt_pk_bf16_f32 v182, v90, v91
    v_cvt_pk_bf16_f32 v183, v92, v93
    v_mfma_f32_32x32x4_2b_bf16 v[62:93], v[222:223], v[166:167], v[94:125] cbsz:1 abid:1
    s_setprio 0
    s_add_u32 s64, s61, 18350080
    buffer_load_dword v246, v245, s[4:7], s64 offen sc1
    v_exp_f32 v30, v30
    v_exp_f32 v31, v31
    v_exp_f32 v32, v32
    v_exp_f32 v33, v33
    v_cvt_pk_bf16_f32 v168, v30, v31
    v_cvt_pk_bf16_f32 v169, v32, v33
    v_exp_f32 v34, v34
    v_exp_f32 v35, v35
    v_exp_f32 v36, v36
    v_exp_f32 v37, v37
    v_cvt_pk_bf16_f32 v170, v34, v35
    v_cvt_pk_bf16_f32 v171, v36, v37
    v_mfma_f32_32x32x16_bf16 v[142:157], v[192:195], v[180:183], v[142:157]
    ds_read_b128 v[192:195], v21 offset:35616
    v_exp_f32 v38, v38
    v_exp_f32 v39, v39
    v_exp_f32 v40, v40
    v_exp_f32 v41, v41
    v_cvt_pk_bf16_f32 v172, v38, v39
    v_cvt_pk_bf16_f32 v173, v40, v41
    s_waitcnt lgkmcnt(1)
    v_mfma_f32_32x32x16_bf16 v[126:141], v[188:191], v[168:171], v[126:141]
    buffer_load_dword v238, v236, s[4:7], s74 offen sc1
    s_add_u32 s74, s74, 28672
    v_exp_f32 v42, v42
    v_exp_f32 v43, v43
    v_exp_f32 v44, v44
    v_exp_f32 v45, v45
    v_cvt_pk_bf16_f32 v174, v42, v43
    v_cvt_pk_bf16_f32 v175, v44, v45
    v_mfma_f32_32x32x16_bf16 v[62:77], v[184:187], v[158:161], v[62:77]
    buffer_load_dword v239, v236, s[4:7], s74 offen sc1
    s_add_u32 s74, s74, 28672
    v_exp_f32 v46, v46
    v_exp_f32 v47, v47
    v_exp_f32 v48, v48
    v_exp_f32 v49, v49
    v_cvt_pk_bf16_f32 v176, v46, v47
    v_cvt_pk_bf16_f32 v177, v48, v49
    s_waitcnt lgkmcnt(0)
    v_mfma_f32_32x32x16_bf16 v[126:141], v[192:195], v[172:175], v[126:141]
    buffer_load_dword v240, v236, s[4:7], s74 offen sc1
    s_add_u32 s74, s74, 28672
    v_exp_f32 v50, v50
    v_exp_f32 v51, v51
    v_exp_f32 v52, v52
    v_exp_f32 v53, v53
    v_cvt_pk_bf16_f32 v178, v50, v51
    v_cvt_pk_bf16_f32 v179, v52, v53
    v_mfma_f32_32x32x16_bf16 v[78:93], v[184:187], v[162:165], v[78:93]
    ds_read_b128 v[184:187], v20 offset:28672
    v_exp_f32 v54, v54
    v_exp_f32 v55, v55
    v_exp_f32 v56, v56
    v_exp_f32 v57, v57
    v_cvt_pk_bf16_f32 v180, v54, v55
    v_cvt_pk_bf16_f32 v181, v56, v57
    v_mfma_f32_32x32x16_bf16 v[142:157], v[188:191], v[176:179], v[142:157]
    ds_read_b128 v[188:191], v21 offset:36288
    v_exp_f32 v58, v58
    v_exp_f32 v59, v59
    v_exp_f32 v60, v60
    v_exp_f32 v61, v61
    v_cvt_pk_bf16_f32 v182, v58, v59
    v_cvt_pk_bf16_f32 v183, v60, v61
    v_mfma_f32_32x32x4_2b_bf16 v[30:61], v[224:225], v[166:167], v[94:125] cbsz:1 abid:0
    s_add_u32 s64, s61, 18874368
    s_min_u32 s64, s64, 19068928
    buffer_load_dword v246, v245, s[4:7], s64 offen sc1
    v_exp_f32 v62, v62
    v_exp_f32 v63, v63
    v_exp_f32 v64, v64
    v_exp_f32 v65, v65
    v_cvt_pk_bf16_f32 v168, v62, v63
    v_cvt_pk_bf16_f32 v169, v64, v65
    v_exp_f32 v66, v66
    v_exp_f32 v67, v67
    v_exp_f32 v68, v68
    v_exp_f32 v69, v69
    v_cvt_pk_bf16_f32 v170, v66, v67
    v_cvt_pk_bf16_f32 v171, v68, v69
    v_mfma_f32_32x32x16_bf16 v[142:157], v[192:195], v[180:183], v[142:157]
    ds_read_b128 v[192:195], v21 offset:36960
    v_exp_f32 v70, v70
    v_exp_f32 v71, v71
    v_exp_f32 v72, v72
    v_exp_f32 v73, v73
    v_cvt_pk_bf16_f32 v172, v70, v71
    v_cvt_pk_bf16_f32 v173, v72, v73
    s_waitcnt lgkmcnt(1)
    v_mfma_f32_32x32x16_bf16 v[126:141], v[188:191], v[168:171], v[126:141]
    buffer_load_dword v241, v236, s[4:7], s74 offen sc1
    s_add_u32 s74, s74, 28672
    v_exp_f32 v74, v74
    v_exp_f32 v75, v75
    v_exp_f32 v76, v76
    v_exp_f32 v77, v77
    v_cvt_pk_bf16_f32 v174, v74, v75
    v_cvt_pk_bf16_f32 v175, v76, v77
    v_mfma_f32_32x32x16_bf16 v[30:45], v[184:187], v[158:161], v[30:45]
    buffer_load_dword v242, v236, s[4:7], s74 offen sc1
    s_add_u32 s74, s74, 28672
    v_exp_f32 v78, v78
    v_exp_f32 v79, v79
    v_exp_f32 v80, v80
    v_exp_f32 v81, v81
    v_cvt_pk_bf16_f32 v176, v78, v79
    v_cvt_pk_bf16_f32 v177, v80, v81
    s_waitcnt lgkmcnt(0)
    v_mfma_f32_32x32x16_bf16 v[126:141], v[192:195], v[172:175], v[126:141]
    v_exp_f32 v82, v82
    v_exp_f32 v83, v83
    v_exp_f32 v84, v84
    v_exp_f32 v85, v85
    v_cvt_pk_bf16_f32 v178, v82, v83
    v_cvt_pk_bf16_f32 v179, v84, v85
    v_mfma_f32_32x32x16_bf16 v[46:61], v[184:187], v[162:165], v[46:61]
    ds_read_b128 v[184:187], v20 offset:29696
    v_exp_f32 v86, v86
    v_exp_f32 v87, v87
    v_exp_f32 v88, v88
    v_exp_f32 v89, v89
    v_cvt_pk_bf16_f32 v180, v86, v87
    v_cvt_pk_bf16_f32 v181, v88, v89
    v_mfma_f32_32x32x16_bf16 v[142:157], v[188:191], v[176:179], v[142:157]
    ds_read_b128 v[188:191], v21 offset:37632
    v_exp_f32 v90, v90
    v_exp_f32 v91, v91
    v_exp_f32 v92, v92
    v_exp_f32 v93, v93
    v_cvt_pk_bf16_f32 v182, v90, v91
    v_cvt_pk_bf16_f32 v183, v92, v93
    s_waitcnt vmcnt(7)
    s_barrier
    v_mfma_f32_32x32x4_2b_bf16 v[62:93], v[224:225], v[166:167], v[94:125] cbsz:1 abid:1
    s_setprio 3
    s_add_u32 m0, s66, 20480
    s_add_u32 s65, m0, s67
    buffer_load_dwordx4 v2, s[4:7], s65 offen sc1 lds
    v_exp_f32 v30, v30
    v_exp_f32 v31, v31
    v_exp_f32 v32, v32
    v_exp_f32 v33, v33
    v_cvt_pk_bf16_f32 v168, v30, v31
    v_cvt_pk_bf16_f32 v169, v32, v33
    v_exp_f32 v34, v34
    v_exp_f32 v35, v35
    v_exp_f32 v36, v36
    v_exp_f32 v37, v37
    v_cvt_pk_bf16_f32 v170, v34, v35
    v_cvt_pk_bf16_f32 v171, v36, v37
    v_mfma_f32_32x32x16_bf16 v[142:157], v[192:195], v[180:183], v[142:157]
    ds_read_b128 v[192:195], v21 offset:38304
    v_exp_f32 v38, v38
    v_exp_f32 v39, v39
    v_exp_f32 v40, v40
    v_exp_f32 v41, v41
    v_cvt_pk_bf16_f32 v172, v38, v39
    v_cvt_pk_bf16_f32 v173, v40, v41
    s_waitcnt lgkmcnt(1)
    v_mfma_f32_32x32x16_bf16 v[126:141], v[188:191], v[168:171], v[126:141]
    s_add_u32 m0, s66, 53248
    s_add_u32 s65, m0, s67
    buffer_load_dwordx4 v2, s[4:7], s65 offen sc1 lds
    v_exp_f32 v42, v42
    v_exp_f32 v43, v43
    v_exp_f32 v44, v44
    v_exp_f32 v45, v45
    v_cvt_pk_bf16_f32 v174, v42, v43
    v_cvt_pk_bf16_f32 v175, v44, v45
    v_mfma_f32_32x32x16_bf16 v[62:77], v[184:187], v[158:161], v[62:77]
    ds_read_b128 v[196:199], v20 offset:0
    ds_read_b128 v[200:203], v20 offset:1024
    v_exp_f32 v46, v46
    v_exp_f32 v47, v47
    v_exp_f32 v48, v48
    v_exp_f32 v49, v49
    v_cvt_pk_bf16_f32 v176, v46, v47
    v_cvt_pk_bf16_f32 v177, v48, v49
    s_waitcnt lgkmcnt(0)
    v_mfma_f32_32x32x16_bf16 v[126:141], v[192:195], v[172:175], v[126:141]
    ds_read_b128 v[204:207], v20 offset:2048
    ds_read_b128 v[208:211], v20 offset:3072
    v_exp_f32 v50, v50
    v_exp_f32 v51, v51
    v_exp_f32 v52, v52
    v_exp_f32 v53, v53
    v_cvt_pk_bf16_f32 v178, v50, v51
    v_cvt_pk_bf16_f32 v179, v52, v53
    v_mfma_f32_32x32x16_bf16 v[78:93], v[184:187], v[162:165], v[78:93]
    ds_read_b128 v[184:187], v20 offset:30720
    v_exp_f32 v54, v54
    v_exp_f32 v55, v55
    v_exp_f32 v56, v56
    v_exp_f32 v57, v57
    v_cvt_pk_bf16_f32 v180, v54, v55
    v_cvt_pk_bf16_f32 v181, v56, v57
    v_mfma_f32_32x32x16_bf16 v[142:157], v[188:191], v[176:179], v[142:157]
    ds_read_b128 v[188:191], v21 offset:38976
    v_exp_f32 v58, v58
    v_exp_f32 v59, v59
    v_exp_f32 v60, v60
    v_exp_f32 v61, v61
    v_cvt_pk_bf16_f32 v182, v58, v59
    v_cvt_pk_bf16_f32 v183, v60, v61
    v_mfma_f32_32x32x4_2b_bf16 v[30:61], v[226:227], v[166:167], v[94:125] cbsz:1 abid:0
    ds_read_b128 v[212:215], v20 offset:4096
    v_exp_f32 v62, v62
    v_exp_f32 v63, v63
    v_exp_f32 v64, v64
    v_exp_f32 v65, v65
    v_cvt_pk_bf16_f32 v168, v62, v63
    v_cvt_pk_bf16_f32 v169, v64, v65
    v_exp_f32 v66, v66
    v_exp_f32 v67, v67
    v_exp_f32 v68, v68
    v_exp_f32 v69, v69
    v_cvt_pk_bf16_f32 v170, v66, v67
    v_cvt_pk_bf16_f32 v171, v68, v69
    v_mfma_f32_32x32x16_bf16 v[142:157], v[192:195], v[180:183], v[142:157]
    ds_read_b128 v[192:195], v21 offset:39648
    v_exp_f32 v70, v70
    v_exp_f32 v71, v71
    v_exp_f32 v72, v72
    v_exp_f32 v73, v73
    v_cvt_pk_bf16_f32 v172, v70, v71
    v_cvt_pk_bf16_f32 v173, v72, v73
    s_waitcnt lgkmcnt(1)
    v_mfma_f32_32x32x16_bf16 v[126:141], v[188:191], v[168:171], v[126:141]
    ds_read_b128 v[216:219], v20 offset:5120
    v_exp_f32 v74, v74
    v_exp_f32 v75, v75
    v_exp_f32 v76, v76
    v_exp_f32 v77, v77
    v_cvt_pk_bf16_f32 v174, v74, v75
    v_cvt_pk_bf16_f32 v175, v76, v77
    v_mfma_f32_32x32x16_bf16 v[30:45], v[184:187], v[158:161], v[30:45]
    ds_read_b128 v[220:223], v20 offset:6144
    v_exp_f32 v78, v78
    v_exp_f32 v79, v79
    v_exp_f32 v80, v80
    v_exp_f32 v81, v81
    v_cvt_pk_bf16_f32 v176, v78, v79
    v_cvt_pk_bf16_f32 v177, v80, v81
    s_waitcnt lgkmcnt(0)
    v_mfma_f32_32x32x16_bf16 v[126:141], v[192:195], v[172:175], v[126:141]
    s_waitcnt vmcnt(2)
    v_add_f32 v13, v238, v239
    v_add_f32 v240, v240, v241
    v_add_f32 v13, v13, v242
    v_and_b32 v0, 0xffff0000, v0
    v_add_f32 v13, v13, v240
    v_mov_b32 v238, v13
    s_nop 1
    v_permlane16_swap_b32 v13, v238
    v_add_f32 v13, v13, v238
    v_mov_b32 v238, v13
    s_nop 1
    v_permlane32_swap_b32 v13, v238
    v_add_f32 v13, v13, v238
    v_exp_f32 v82, v82
    v_exp_f32 v83, v83
    v_exp_f32 v84, v84
    v_exp_f32 v85, v85
    v_cvt_pk_bf16_f32 v178, v82, v83
    v_cvt_pk_bf16_f32 v179, v84, v85
    v_mfma_f32_32x32x16_bf16 v[46:61], v[184:187], v[162:165], v[46:61]
    ds_read_b128 v[184:187], v20 offset:31744
    v_exp_f32 v86, v86
    v_exp_f32 v87, v87
    v_exp_f32 v88, v88
    v_exp_f32 v89, v89
    v_cvt_pk_bf16_f32 v180, v86, v87
    v_cvt_pk_bf16_f32 v181, v88, v89
    v_mfma_f32_32x32x16_bf16 v[142:157], v[188:191], v[176:179], v[142:157]
    ds_read_b128 v[188:191], v21 offset:40320
    v_exp_f32 v90, v90
    v_exp_f32 v91, v91
    v_exp_f32 v92, v92
    v_exp_f32 v93, v93
    v_cvt_pk_bf16_f32 v182, v90, v91
    v_cvt_pk_bf16_f32 v183, v92, v93
    v_mfma_f32_32x32x4_2b_bf16 v[62:93], v[226:227], v[166:167], v[94:125] cbsz:1 abid:1
    s_setprio 2
    ds_read_b128 v[228:231], v20 offset:7168
    v_exp_f32 v30, v30
    v_exp_f32 v31, v31
    v_exp_f32 v32, v32
    v_exp_f32 v33, v33
    v_cvt_pk_bf16_f32 v168, v30, v31
    v_cvt_pk_bf16_f32 v169, v32, v33
    v_exp_f32 v34, v34
    v_exp_f32 v35, v35
    v_exp_f32 v36, v36
    v_exp_f32 v37, v37
    v_cvt_pk_bf16_f32 v170, v34, v35
    v_cvt_pk_bf16_f32 v171, v36, v37
    v_mfma_f32_32x32x16_bf16 v[142:157], v[192:195], v[180:183], v[142:157]
    ds_read_b128 v[192:195], v21 offset:40992
    v_exp_f32 v38, v38
    v_exp_f32 v39, v39
    v_exp_f32 v40, v40
    v_exp_f32 v41, v41
    v_cvt_pk_bf16_f32 v172, v38, v39
    v_cvt_pk_bf16_f32 v173, v40, v41
    s_waitcnt lgkmcnt(1)
    v_mfma_f32_32x32x16_bf16 v[126:141], v[188:191], v[168:171], v[126:141]
    ds_read_b128 v[232:235], v20 offset:8192
    v_exp_f32 v42, v42
    v_exp_f32 v43, v43
    v_exp_f32 v44, v44
    v_exp_f32 v45, v45
    v_cvt_pk_bf16_f32 v174, v42, v43
    v_cvt_pk_bf16_f32 v175, v44, v45
    v_mfma_f32_32x32x16_bf16 v[62:77], v[184:187], v[158:161], v[62:77]
    ds_read_b128 v[248:251], v20 offset:9216
    v_exp_f32 v46, v46
    v_exp_f32 v47, v47
    v_exp_f32 v48, v48
    v_exp_f32 v49, v49
    v_cvt_pk_bf16_f32 v176, v46, v47
    v_cvt_pk_bf16_f32 v177, v48, v49
    s_waitcnt lgkmcnt(0)
    v_mfma_f32_32x32x16_bf16 v[126:141], v[192:195], v[172:175], v[126:141]
    ds_read_b128 v[252:255], v20 offset:10240
    v_exp_f32 v50, v50
    v_exp_f32 v51, v51
    v_exp_f32 v52, v52
    v_exp_f32 v53, v53
    v_cvt_pk_bf16_f32 v178, v50, v51
    v_cvt_pk_bf16_f32 v179, v52, v53
    v_mfma_f32_32x32x16_bf16 v[78:93], v[184:187], v[162:165], v[78:93]
    v_exp_f32 v54, v54
    v_exp_f32 v55, v55
    v_exp_f32 v56, v56
    v_exp_f32 v57, v57
    v_cvt_pk_bf16_f32 v180, v54, v55
    v_cvt_pk_bf16_f32 v181, v56, v57
    v_mfma_f32_32x32x16_bf16 v[142:157], v[188:191], v[176:179], v[142:157]
    ds_read_b128 v[188:191], v21 offset:41664
    v_exp_f32 v58, v58
    v_exp_f32 v59, v59
    v_exp_f32 v60, v60
    v_exp_f32 v61, v61
    v_cvt_pk_bf16_f32 v182, v58, v59
    v_cvt_pk_bf16_f32 v183, v60, v61
    s_setprio 1
    ds_read_b128 v[96:99], v20 offset:11264
    ds_read_b128 v[100:103], v20 offset:12288
    v_exp_f32 v62, v62
    v_exp_f32 v63, v63
    v_exp_f32 v64, v64
    v_exp_f32 v65, v65
    v_cvt_pk_bf16_f32 v168, v62, v63
    v_cvt_pk_bf16_f32 v169, v64, v65
    ds_read_b128 v[104:107], v20 offset:13312
    ds_read_b128 v[108:111], v20 offset:14336
    v_exp_f32 v66, v66
    v_exp_f32 v67, v67
    v_exp_f32 v68, v68
    v_exp_f32 v69, v69
    v_cvt_pk_bf16_f32 v170, v66, v67
    v_cvt_pk_bf16_f32 v171, v68, v69
    v_mfma_f32_32x32x16_bf16 v[142:157], v[192:195], v[180:183], v[142:157]
    ds_read_b128 v[192:195], v21 offset:42336
    v_exp_f32 v70, v70
    v_exp_f32 v71, v71
    v_exp_f32 v72, v72
    v_exp_f32 v73, v73
    v_cvt_pk_bf16_f32 v172, v70, v71
    v_cvt_pk_bf16_f32 v173, v72, v73
    s_waitcnt lgkmcnt(1)
    v_mfma_f32_32x32x16_bf16 v[126:141], v[188:191], v[168:171], v[126:141]
    ds_read_b128 v[112:115], v20 offset:15360
    ds_read_b128 v[116:119], v20 offset:16384
    v_exp_f32 v74, v74
    v_exp_f32 v75, v75
    v_exp_f32 v76, v76
    v_exp_f32 v77, v77
    v_cvt_pk_bf16_f32 v174, v74, v75
    v_cvt_pk_bf16_f32 v175, v76, v77
    ds_read_b128 v[120:123], v20 offset:17408
    ds_read_b128 v[224:227], v20 offset:18432
    v_exp_f32 v78, v78
    v_exp_f32 v79, v79
    v_exp_f32 v80, v80
    v_exp_f32 v81, v81
    v_cvt_pk_bf16_f32 v176, v78, v79
    v_cvt_pk_bf16_f32 v177, v80, v81
    s_waitcnt lgkmcnt(0)
    v_mfma_f32_32x32x16_bf16 v[126:141], v[192:195], v[172:175], v[126:141]
    ds_read_b128 v[236:239], v20 offset:19456
    ds_read_b128 v[240:243], v26 offset:0
    v_exp_f32 v82, v82
    v_exp_f32 v83, v83
    v_exp_f32 v84, v84
    v_exp_f32 v85, v85
    v_cvt_pk_bf16_f32 v178, v82, v83
    v_cvt_pk_bf16_f32 v179, v84, v85
    ds_read_b128 v[244:247], v26 offset:1024
    ds_read_b128 v[48:51], v26 offset:2048
    v_exp_f32 v86, v86
    v_exp_f32 v87, v87
    v_exp_f32 v88, v88
    v_exp_f32 v89, v89
    v_cvt_pk_bf16_f32 v180, v86, v87
    v_cvt_pk_bf16_f32 v181, v88, v89
    v_mfma_f32_32x32x16_bf16 v[142:157], v[188:191], v[176:179], v[142:157]
    ds_read_b128 v[52:55], v26 offset:3072
    ds_read_b128 v[56:59], v26 offset:4096
    v_exp_f32 v90, v90
    v_exp_f32 v91, v91
    v_exp_f32 v92, v92
    v_exp_f32 v93, v93
    v_cvt_pk_bf16_f32 v182, v90, v91
    v_cvt_pk_bf16_f32 v183, v92, v93
    s_nop 1
    v_mfma_f32_32x32x16_bf16 v[142:157], v[192:195], v[180:183], v[142:157]
    s_setprio 0
    s_cmp_lg_u32 s24, 0
    s_cbranch_scc1 L_sequ_kh_42
    ds_read_b128 v[60:63], v26 offset:5120
    ds_read_b128 v[64:67], v26 offset:6144
    ds_read_b128 v[68:71], v26 offset:7168
    ds_read_b128 v[72:75], v26 offset:8192
    ds_read_b128 v[76:79], v26 offset:9216
    ds_read_b128 v[80:83], v26 offset:10240
    ds_read_b128 v[84:87], v26 offset:11264
    ds_read_b128 v[88:91], v26 offset:12288
    ds_read_b128 v[92:95], v26 offset:13312
    ds_read_b128 v[168:171], v26 offset:14336
    ds_read_b128 v[172:175], v26 offset:15360
    ds_read_b128 v[176:179], v26 offset:16384
    ds_read_b128 v[180:183], v26 offset:17408
    ds_read_b128 v[184:187], v26 offset:18432
    ds_read_b128 v[188:191], v26 offset:19456
    ds_read_b128 v[192:195], v26 offset:20480
L_sequ_kh_42:
    v_maximum3_f32 v5, abs(v126), abs(v127), abs(v128)
    v_maximum3_f32 v5, v5, abs(v129), abs(v130)
    v_maximum3_f32 v5, v5, abs(v131), abs(v132)
    v_maximum3_f32 v5, v5, abs(v133), abs(v134)
    v_maximum3_f32 v5, v5, abs(v135), abs(v136)
    s_nop 3
    v_maximum3_f32 v6, abs(v142), abs(v143), abs(v144)
    v_maximum3_f32 v6, v6, abs(v145), abs(v146)
    v_maximum3_f32 v6, v6, abs(v147), abs(v148)
    v_maximum3_f32 v6, v6, abs(v149), abs(v150)
    v_maximum3_f32 v6, v6, abs(v151), abs(v152)
    v_maximum3_f32 v5, v5, abs(v137), abs(v153)
    v_maximum3_f32 v5, v5, v6, v6
    v_max_f32 v7, v134, v150
    v_min_f32 v8, v134, v150
    s_mov_b32 s50, 0x7b800000
    s_mov_b32 s51, 0x5d800000
    s_mov_b32 s52, 0x35800000
    v_cmp_nlt_f32 vcc, v5, s50
    v_cmp_nlt_f32 s[54:55], v7, s51
    v_cmp_ngt_f32 s[56:57], v8, s52
    s_or_b32 s55, s55, s57
    s_or_b32 s55, s55, vcc_hi
    s_or_b32 s55, s55, vcc_lo
    s_cmp_lg_u32 s55, 0
    s_cbranch_scc1 L_mega_slow
L_mega_ep:
    s_mov_b32 s76, 0
    s_mov_b32 s77, -1
    s_cmp_eq_u32 s24, 1
    s_cbranch_scc1 L_mega_epB
    v_cndmask_b32 v151, v151, v23, s[76:77]
    ds_write_b128 v27, v[142:145] offset:0
    ds_write_b128 v27, v[146:149] offset:1024
    ds_write_b128 v27, v[150:153] offset:2048
    ds_read_b128 v[160:163], v26 offset:21504
    ds_read_b128 v[164:167], v26 offset:22528
    s_waitcnt lgkmcnt(0)
    s_barrier
    ds_read_b128 v[38:41], v28 offset:2048
    ds_read_b128 v[30:33], v28 offset:0
    ds_read_b128 v[34:37], v28 offset:1024
    s_add_u32 m0, s66, 0
    s_add_u32 s65, m0, s67
    buffer_load_dwordx4 v2, s[4:7], s65 offen sc1 lds
    s_add_u32 m0, s66, 8192
    s_add_u32 s65, m0, s67
    buffer_load_dwordx4 v2, s[4:7], s65 offen sc1 lds
    s_add_u32 m0, s66, 12288
    s_add_u32 s65, m0, s67
    buffer_load_dwordx4 v2, s[4:7], s65 offen sc1 lds
    s_waitcnt lgkmcnt(2)
    v_mov_b32 v7, v39
    v_mov_b32 v8, v39
    s_nop 1
    v_permlane32_swap_b32 v8, v7
    v_max_f32 v8, v22, v7
    v_sub_f32 v9, v22, v8
    v_sub_f32 v7, v7, v8
    v_exp_f32 v9, v9
    v_exp_f32 v7, v7
    v_mul_f32 v5, v134, v9
    v_fma_f32 v5, v38, v7, v5
    v_mov_b32 v8, v5
    s_nop 1
    v_permlane32_swap_b32 v5, v8
    v_rcp_f32 v8, v8
    s_nop 0
    v_mul_f32 v42, v9, v8
    v_mul_f32 v44, v7, v8
    s_waitcnt lgkmcnt(0)
    v_pk_mul_f32 v[30:31], v[30:31], v[44:45] op_sel_hi:[1,0]
    v_pk_fma_f32 v[30:31], v[126:127], v[42:43], v[30:31] op_sel_hi:[1,0,1]
    v_pk_mul_f32 v[32:33], v[32:33], v[44:45] op_sel_hi:[1,0]
    v_pk_fma_f32 v[32:33], v[128:129], v[42:43], v[32:33] op_sel_hi:[1,0,1]
    v_pk_mul_f32 v[34:35], v[34:35], v[44:45] op_sel_hi:[1,0]
    v_pk_fma_f32 v[34:35], v[130:131], v[42:43], v[34:35] op_sel_hi:[1,0,1]
    v_pk_mul_f32 v[36:37], v[36:37], v[44:45] op_sel_hi:[1,0]
    v_pk_fma_f32 v[36:37], v[132:133], v[42:43], v[36:37] op_sel_hi:[1,0,1]
    v_pk_mul_f32 v[38:39], v[38:39], v[44:45] op_sel_hi:[1,0]
    v_pk_fma_f32 v[38:39], v[134:135], v[42:43], v[38:39] op_sel_hi:[1,0,1]
    v_pk_mul_f32 v[40:41], v[40:41], v[44:45] op_sel_hi:[1,0]
    v_pk_fma_f32 v[40:41], v[136:137], v[42:43], v[40:41] op_sel_hi:[1,0,1]
    v_cvt_pk_bf16_f32 v42, v30, v31
    v_cvt_pk_bf16_f32 v43, v32, v33
    v_cvt_pk_bf16_f32 v44, v34, v35
    v_cvt_pk_bf16_f32 v45, v36, v37
    v_cvt_pk_bf16_f32 v46, v38, v39
    v_cvt_pk_bf16_f32 v47, v40, v41
    s_cmp_eq_u32 s35, 1
    s_cbranch_scc0 L_sequ_hs_43
    buffer_store_dwordx4 v[42:45], v24, s[4:7], 0 offen
L_sequ_hb_44:
    s_mov_b32 exec_hi, 0
    s_cmp_eq_u32 s35, 1
    s_cbranch_scc0 L_sequ_hs_45
    buffer_store_dwordx2 v[46:47], v25, s[4:7], 0 offen
L_sequ_hb_46:
    s_mov_b64 exec, -1
    s_branch L_mega_epJ
L_mega_epB:
    v_cndmask_b32 v135, v135, v22, s[76:77]
    ds_write_b128 v27, v[126:129] offset:0
    ds_write_b128 v27, v[130:133] offset:1024
    ds_write_b128 v27, v[134:137] offset:2048
    s_waitcnt lgkmcnt(0)
    s_barrier
    ds_read_b128 v[38:41], v28 offset:2048
    ds_read_b128 v[30:33], v28 offset:0
    ds_read_b128 v[34:37], v28 offset:1024
    s_add_u32 m0, s66, 0
    s_add_u32 s65, m0, s67
    buffer_load_dwordx4 v2, s[4:7], s65 offen sc1 lds
    s_add_u32 m0, s66, 8192
    s_add_u32 s65, m0, s67
    buffer_load_dwordx4 v2, s[4:7], s65 offen sc1 lds
    s_add_u32 m0, s66, 12288
    s_add_u32 s65, m0, s67
    buffer_load_dwordx4 v2, s[4:7], s65 offen sc1 lds
    s_waitcnt lgkmcnt(2)
    v_mov_b32 v7, v39
    v_mov_b32 v8, v39
    s_nop 1
    v_permlane32_swap_b32 v8, v7
    v_max_f32 v8, v23, v7
    v_sub_f32 v9, v23, v8
    v_sub_f32 v7, v7, v8
    v_exp_f32 v9, v9
    v_exp_f32 v7, v7
    v_mul_f32 v5, v150, v9
    v_fma_f32 v5, v38, v7, v5
    v_mov_b32 v8, v5
    s_nop 1
    v_permlane32_swap_b32 v5, v8
    v_rcp_f32 v8, v8
    s_nop 0
    v_mul_f32 v42, v9, v8
    v_mul_f32 v44, v7, v8
    s_waitcnt lgkmcnt(0)
    v_pk_mul_f32 v[30:31], v[30:31], v[44:45] op_sel_hi:[1,0]
    v_pk_fma_f32 v[30:31], v[142:143], v[42:43], v[30:31] op_sel_hi:[1,0,1]
    v_pk_mul_f32 v[32:33], v[32:33], v[44:45] op_sel_hi:[1,0]
    v_pk_fma_f32 v[32:33], v[144:145], v[42:43], v[32:33] op_sel_hi:[1,0,1]
    v_pk_mul_f32 v[34:35], v[34:35], v[44:45] op_sel_hi:[1,0]
    v_pk_fma_f32 v[34:35], v[146:147], v[42:43], v[34:35] op_sel_hi:[1,0,1]
    v_pk_mul_f32 v[36:37], v[36:37], v[44:45] op_sel_hi:[1,0]
    v_pk_fma_f32 v[36:37], v[148:149], v[42:43], v[36:37] op_sel_hi:[1,0,1]
    v_pk_mul_f32 v[38:39], v[38:39], v[44:45] op_sel_hi:[1,0]
    v_pk_fma_f32 v[38:39], v[150:151], v[42:43], v[38:39] op_sel_hi:[1,0,1]
    v_pk_mul_f32 v[40:41], v[40:41], v[44:45] op_sel_hi:[1,0]
    v_pk_fma_f32 v[40:41], v[152:153], v[42:43], v[40:41] op_sel_hi:[1,0,1]
    v_cvt_pk_bf16_f32 v42, v30, v31
    v_cvt_pk_bf16_f32 v43, v32, v33
    v_cvt_pk_bf16_f32 v44, v34, v35
    v_cvt_pk_bf16_f32 v45, v36, v37
    v_cvt_pk_bf16_f32 v46, v38, v39
    v_cvt_pk_bf16_f32 v47, v40, v41
    s_cmp_eq_u32 s35, 1
    s_cbranch_scc0 L_sequ_hs_47
    buffer_store_dwordx4 v[42:45], v24, s[4:7], 0 offen
L_sequ_hb_48:
    s_mov_b32 exec_hi, 0
    s_cmp_eq_u32 s35, 1
    s_cbranch_scc0 L_sequ_hs_49
    buffer_store_dwordx2 v[46:47], v25, s[4:7], 0 offen
L_sequ_hb_50:
    s_mov_b64 exec, -1
L_mega_epJ:
    ds_read_b128 v[156:159], v26 offset:23552
    s_add_u32 s31, s62, 19922944
    s_add_u32 m0, s66, 28672
    s_add_u32 s65, m0, s67
    buffer_load_dwordx4 v2, s[4:7], s65 offen sc1 nt lds
    s_add_u32 m0, s66, 36864
    s_add_u32 s65, m0, s67
    buffer_load_dwordx4 v2, s[4:7], s65 offen sc1 nt lds
    s_add_u32 m0, s66, 45056
    s_add_u32 s65, m0, s67
    buffer_load_dwordx4 v2, s[4:7], s65 offen sc1 nt lds
    s_mul_i32 s50, s24, 6144
    s_add_u32 s50, s50, 151552
    v_add_u32 v7, s50, v2
    s_lshl_b32 s50, s21, 7
    s_add_u32 s50, s50, 22545408
    s_lshl_b32 s51, s22, 2
    s_add_u32 s51, s51, s50
    s_mul_i32 s52, s79, 20480
    s_mul_i32 s53, s24, 10240
    s_add_u32 s52, s52, s53
    s_add_u32 s52, s52, 3145728
    s_add_u32 s53, s52, 4096
    s_add_u32 s54, s52, 8192
    s_waitcnt vmcnt(3)
    s_waitcnt lgkmcnt(0)
    s_barrier
    s_cmp_lg_u32 s20, 0
    s_cbranch_scc1 L_sequ_w0_51
    v_mov_b32 v11, 0
    v_mov_b32 v12, s3
    s_mov_b64 exec, 1
    s_cmp_eq_u32 s35, 1
    s_cbranch_scc0 L_sequ_hs_52
    buffer_store_dword v12, v11, s[4:7], s51 offen
L_sequ_hb_53:
    s_mov_b64 exec, -1
L_sequ_w0_51:
    s_cmp_lg_u32 s24, 1
    s_cbranch_scc1 L_sequ_kh_54
    ds_read_b128 v[60:63], v26 offset:5120
    ds_read_b128 v[64:67], v26 offset:6144
    ds_read_b128 v[68:71], v26 offset:7168
    ds_read_b128 v[72:75], v26 offset:8192
    ds_read_b128 v[76:79], v26 offset:9216
    ds_read_b128 v[80:83], v26 offset:10240
    ds_read_b128 v[84:87], v26 offset:11264
    ds_read_b128 v[88:91], v26 offset:12288
    ds_read_b128 v[92:95], v26 offset:13312
    ds_read_b128 v[168:171], v26 offset:14336
    ds_read_b128 v[172:175], v26 offset:15360
    ds_read_b128 v[176:179], v26 offset:16384
    ds_read_b128 v[180:183], v26 offset:17408
    ds_read_b128 v[184:187], v26 offset:18432
    ds_read_b128 v[188:191], v26 offset:19456
    ds_read_b128 v[192:195], v26 offset:20480
    ds_read_b128 v[160:163], v26 offset:21504
    ds_read_b128 v[164:167], v26 offset:22528
L_sequ_kh_54:
    s_cmp_eq_u32 s20, 0
    s_cbranch_scc1 L_mega_sk0
    s_add_u32 m0, s66, 61440
    s_add_u32 s65, m0, s67
    buffer_load_dwordx4 v2, s[4:7], s65 offen sc1 nt lds
    s_add_u32 m0, s66, 69632
    s_add_u32 s65, m0, s67
    buffer_load_dwordx4 v2, s[4:7], s65 offen sc1 nt lds
    s_add_u32 m0, s66, 77824
    s_add_u32 s65, m0, s67
    buffer_load_dwordx4 v2, s[4:7], s65 offen sc1 nt lds
    s_add_u32 m0, s66, 86016
    s_add_u32 s65, m0, s67
    buffer_load_dwordx4 v2, s[4:7], s65 offen sc1 nt lds
    s_add_u32 m0, s66, 94208
    s_add_u32 s65, m0, s67
    s_waitcnt vmcnt(6)
    buffer_load_dwordx4 v2, s[4:7], s65 offen sc1 nt lds
    s_add_u32 m0, s66, 102400
    s_add_u32 s65, m0, s67
    s_waitcnt vmcnt(6)
    buffer_load_dwordx4 v2, s[4:7], s65 offen sc1 nt lds
    s_add_u32 m0, s66, 135168
    s_add_u32 s65, m0, s67
    s_waitcnt vmcnt(6)
    buffer_load_dwordx4 v2, s[4:7], s65 offen sc1 nt lds
    s_lshl_b32 s65, s20, 13
    s_add_u32 s65, s65, 53248
    s_cmp_eq_u32 s20, 7
    s_cselect_b32 m0, 135168, s65
    s_add_u32 s65, m0, s67
    s_waitcnt vmcnt(6)
    buffer_load_dwordx4 v2, s[4:7], s65 offen sc1 nt lds
L_mega_sk0:
    s_cmp_lg_u32 s20, 0
    s_cbranch_scc1 L_sequ_w0_55
    v_lshlrev_b32 v11, 2, v1
    s_mov_b64 exec, 255
    s_mov_b32 s78, 0
L_sequ_poll_56:
    buffer_load_dword v12, v11, s[4:7], s50 offen sc1
    s_add_u32 s78, s78, 1
    s_waitcnt vmcnt(0)
    v_cmp_ne_u32 vcc, s3, v12
    s_cmp_gt_u32 s78, 0x40000
    s_cbranch_scc1 L_sequ_polld_57
    s_cbranch_vccnz L_sequ_poll_56
L_sequ_polld_57:
    s_mov_b64 exec, -1
L_sequ_w0_55:
    s_waitcnt lgkmcnt(0)
    s_barrier
    s_waitcnt vmcnt(6)
    buffer_load_dwordx4 v[20:23], v2, s[4:7], s52 offen offset:0 sc1
    s_waitcnt vmcnt(6)
    buffer_load_dwordx4 v[24:27], v2, s[4:7], s52 offen offset:1024 sc1
    s_waitcnt vmcnt(6)
    buffer_load_dwordx4 v[28:31], v2, s[4:7], s52 offen offset:2048 sc1
    s_waitcnt vmcnt(6)
    buffer_load_dwordx4 v[32:35], v2, s[4:7], s52 offen offset:3072 sc1
    s_waitcnt vmcnt(6)
    buffer_load_dwordx4 v[36:39], v2, s[4:7], s53 offen offset:0 sc1
    s_waitcnt vmcnt(6)
    buffer_load_dwordx4 v[40:43], v2, s[4:7], s53 offen offset:1024 sc1
    s_mul_i32 s62, s23, 5120
    s_add_u32 s62, s62, 143360
    s_lshl_b32 s63, s24, 11
    s_add_u32 s62, s62, s63
    v_add_u32 v5, s62, v2
    s_sub_u32 s62, s62, s63
    s_sub_u32 s62, s62, s63
    s_add_u32 s62, s62, 2048
    v_add_u32 v6, s62, v2
    s_mul_i32 s74, s79, 20480
    s_add_u32 s74, s74, 5767168
    s_lshl_b32 s75, s22, 1
    s_add_u32 s75, s75, s24
    s_lshl_b32 s68, s75, 10
    s_add_u32 s68, s68, s74
    s_lshl_b32 s69, s22, 9
    s_add_u32 s69, s69, s74
    s_add_u32 s69, s69, 16384
    s_lshl_b32 s70, s79, 11
    s_lshl_b32 s75, s75, 7
    s_add_u32 s70, s70, s75
    s_add_u32 s70, s70, 22675456
    s_lshl_b32 s74, s80, 3
    s_add_u32 s74, s74, s20
    s_mul_i32 s74, s74, 55296
    s_add_u32 s74, s74, 8388608
    s_mul_i32 s71, s27, 3072
    s_add_u32 s71, s71, s74
    s_lshl_b32 s73, s27, 9
    s_add_u32 s73, s73, s74
    s_add_u32 s73, s73, 47104
    s_cmp_eq_u32 s27, 15
    s_cselect_b32 s72, 0x7f000000, s71
    s_waitcnt vmcnt(5)
    s_setprio 3
    v_mfma_f32_16x16x32_bf16 v[136:139], v[196:199], v[20:23], 0
    v_mfma_f32_16x16x32_bf16 v[140:143], v[200:203], v[20:23], 0
    v_mfma_f32_16x16x32_bf16 v[144:147], v[204:207], v[20:23], 0
    v_mfma_f32_16x16x32_bf16 v[148:151], v[208:211], v[20:23], 0
    v_mfma_f32_16x16x32_bf16 v[152:155], v[212:215], v[20:23], 0
    buffer_load_dwordx4 v[44:47], v2, s[4:7], s53 offen offset:2048 sc1
    s_waitcnt vmcnt(5)
    v_mfma_f32_16x16x32_bf16 v[136:139], v[216:219], v[24:27], v[136:139]
    v_mfma_f32_16x16x32_bf16 v[140:143], v[220:223], v[24:27], v[140:143]
    v_mfma_f32_16x16x32_bf16 v[144:147], v[228:231], v[24:27], v[144:147]
    v_mfma_f32_16x16x32_bf16 v[148:151], v[232:235], v[24:27], v[148:151]
    v_mfma_f32_16x16x32_bf16 v[152:155], v[248:251], v[24:27], v[152:155]
    ds_read_b128 v[196:199], v7 offset:0
    ds_read_b128 v[200:203], v7 offset:1024
    ds_read_b128 v[204:207], v7 offset:2048
    ds_read_b128 v[208:211], v7 offset:3072
    ds_read_b128 v[212:215], v7 offset:4096
    ds_read_b128 v[216:219], v7 offset:5120
    buffer_load_dwordx4 v[124:127], v2, s[4:7], s53 offen offset:3072 sc1
    s_waitcnt vmcnt(5)
    s_setprio 2
    v_mfma_f32_16x16x32_bf16 v[136:139], v[252:255], v[28:31], v[136:139]
    v_mfma_f32_16x16x32_bf16 v[140:143], v[96:99], v[28:31], v[140:143]
    v_mfma_f32_16x16x32_bf16 v[144:147], v[100:103], v[28:31], v[144:147]
    v_mfma_f32_16x16x32_bf16 v[148:151], v[104:107], v[28:31], v[148:151]
    v_mfma_f32_16x16x32_bf16 v[152:155], v[108:111], v[28:31], v[152:155]
    buffer_load_dwordx4 v[128:131], v2, s[4:7], s54 offen offset:0 sc1
    s_waitcnt vmcnt(5)
    s_setprio 1
    v_mfma_f32_16x16x32_bf16 v[136:139], v[112:115], v[32:35], v[136:139]
    v_mfma_f32_16x16x32_bf16 v[140:143], v[116:119], v[32:35], v[140:143]
    v_mfma_f32_16x16x32_bf16 v[144:147], v[120:123], v[32:35], v[144:147]
    v_mfma_f32_16x16x32_bf16 v[148:151], v[224:227], v[32:35], v[148:151]
    v_mfma_f32_16x16x32_bf16 v[152:155], v[236:239], v[32:35], v[152:155]
    buffer_load_dwordx4 v[132:135], v2, s[4:7], s54 offen offset:1024 sc1
    s_waitcnt vmcnt(5)
    s_setprio 0
    v_mfma_f32_16x16x32_bf16 v[136:139], v[240:243], v[36:39], v[136:139]
    v_mfma_f32_16x16x32_bf16 v[140:143], v[244:247], v[36:39], v[140:143]
    v_mfma_f32_16x16x32_bf16 v[144:147], v[48:51], v[36:39], v[144:147]
    v_mfma_f32_16x16x32_bf16 v[148:151], v[52:55], v[36:39], v[148:151]
    v_mfma_f32_16x16x32_bf16 v[152:155], v[56:59], v[36:39], v[152:155]
    s_add_u32 m0, s66, 110592
    s_add_u32 s65, m0, s67
    buffer_load_dwordx4 v2, s[4:7], s65 offen sc1 nt lds
    s_add_u32 m0, s66, 118784
    s_add_u32 s65, m0, s67
    buffer_load_dwordx4 v2, s[4:7], s65 offen sc1 nt lds
    s_waitcnt vmcnt(6)
    s_waitcnt lgkmcnt(0)
    s_barrier
    s_setprio 3
    v_mfma_f32_16x16x32_bf16 v[136:139], v[60:63], v[40:43], v[136:139]
    v_mfma_f32_16x16x32_bf16 v[140:143], v[64:67], v[40:43], v[140:143]
    v_mfma_f32_16x16x32_bf16 v[144:147], v[68:71], v[40:43], v[144:147]
    v_mfma_f32_16x16x32_bf16 v[148:151], v[72:75], v[40:43], v[148:151]
    v_mfma_f32_16x16x32_bf16 v[152:155], v[76:79], v[40:43], v[152:155]
    s_add_u32 m0, s66, 126976
    s_add_u32 s65, m0, s67
    buffer_load_dwordx4 v2, s[4:7], s65 offen sc1 nt lds
    s_waitcnt vmcnt(6)
    v_mfma_f32_16x16x32_bf16 v[136:139], v[80:83], v[44:47], v[136:139]
    v_lshlrev_b32 v96, 16, v14
    v_mfma_f32_16x16x32_bf16 v[140:143], v[84:87], v[44:47], v[140:143]
    v_and_b32 v97, 0xffff0000, v14
    v_mfma_f32_16x16x32_bf16 v[144:147], v[88:91], v[44:47], v[144:147]
    v_lshlrev_b32 v98, 16, v15
    v_mfma_f32_16x16x32_bf16 v[148:151], v[92:95], v[44:47], v[148:151]
    v_and_b32 v99, 0xffff0000, v15
    v_mfma_f32_16x16x32_bf16 v[152:155], v[168:171], v[44:47], v[152:155]
    v_lshlrev_b32 v100, 16, v16
    s_waitcnt vmcnt(5)
    s_setprio 2
    v_mfma_f32_16x16x32_bf16 v[136:139], v[172:175], v[124:127], v[136:139]
    v_and_b32 v101, 0xffff0000, v16
    v_mfma_f32_16x16x32_bf16 v[140:143], v[176:179], v[124:127], v[140:143]
    v_lshlrev_b32 v102, 16, v17
    v_mfma_f32_16x16x32_bf16 v[144:147], v[180:183], v[124:127], v[144:147]
    v_and_b32 v103, 0xffff0000, v17
    v_mfma_f32_16x16x32_bf16 v[148:151], v[184:187], v[124:127], v[148:151]
    v_lshlrev_b32 v104, 16, v18
    v_mfma_f32_16x16x32_bf16 v[152:155], v[188:191], v[124:127], v[152:155]
    v_and_b32 v105, 0xffff0000, v18
    s_waitcnt vmcnt(4)
    s_setprio 1
    v_mfma_f32_16x16x32_bf16 v[136:139], v[192:195], v[128:131], v[136:139]
    v_lshlrev_b32 v106, 16, v19
    v_mfma_f32_16x16x32_bf16 v[140:143], v[160:163], v[128:131], v[140:143]
    v_and_b32 v107, 0xffff0000, v19
    v_mfma_f32_16x16x32_bf16 v[144:147], v[164:167], v[128:131], v[144:147]
    v_mov_b32 v110, 0x3f803f80
    v_mfma_f32_16x16x32_bf16 v[148:151], v[156:159], v[128:131], v[148:151]
    v_mov_b32 v108, 0
    v_mfma_f32_16x16x32_bf16 v[152:155], v[196:199], v[128:131], v[152:155]
    v_mov_b32 v109, 0
    s_waitcnt vmcnt(3)
    s_setprio 0
    v_mfma_f32_16x16x32_bf16 v[136:139], v[200:203], v[132:135], v[136:139]
    v_mfma_f32_16x16x32_bf16 v[140:143], v[204:207], v[132:135], v[140:143]
    v_mfma_f32_16x16x32_bf16 v[144:147], v[208:211], v[132:135], v[144:147]
    v_mfma_f32_16x16x32_bf16 v[148:151], v[212:215], v[132:135], v[148:151]
    v_mfma_f32_16x16x32_bf16 v[152:155], v[216:219], v[132:135], v[152:155]
    s_nop 5
    ds_write_b128 v5, v[144:147] offset:0
    ds_write_b128 v5, v[148:151] offset:1024
    s_cmp_eq_u32 s24, 0
    s_cbranch_scc1 L_sequ_px_58
    ds_write_b128 v5, v[152:155] offset:2048
L_sequ_px_58:
    s_waitcnt vmcnt(0)
    s_waitcnt lgkmcnt(0)
    s_barrier
    ds_read_b128 v[20:23], v6 offset:0
    ds_read_b128 v[24:27], v6 offset:1024
    ds_read_b128 v[28:31], v6 offset:2048
    v_pk_add_f32 v[136:137], v[136:137], v[96:97]
    v_pk_add_f32 v[138:139], v[138:139], v[98:99]
    s_waitcnt lgkmcnt(2)
    v_pk_add_f32 v[136:137], v[136:137], v[20:21]
    v_pk_add_f32 v[138:139], v[138:139], v[22:23]
    v_cvt_pk_bf16_f32 v14, v136, v137
    v_cvt_pk_bf16_f32 v15, v138, v139
    v_pk_add_f32 v[140:141], v[140:141], v[100:101]
    v_pk_add_f32 v[142:143], v[142:143], v[102:103]
    s_waitcnt lgkmcnt(1)
    v_pk_add_f32 v[140:141], v[140:141], v[24:25]
    v_pk_add_f32 v[142:143], v[142:143], v[26:27]
    v_cvt_pk_bf16_f32 v16, v140, v141
    v_cvt_pk_bf16_f32 v17, v142, v143
    buffer_store_dwordx4 v[14:17], v2, s[4:7], s68 offen sc1
    v_dot2c_f32_bf16 v108, v14, v110
    v_dot2c_f32_bf16 v109, v14, v14
    v_dot2c_f32_bf16 v108, v15, v110
    v_dot2c_f32_bf16 v109, v15, v15
    v_dot2c_f32_bf16 v108, v16, v110
    v_dot2c_f32_bf16 v109, v16, v16
    v_dot2c_f32_bf16 v108, v17, v110
    v_dot2c_f32_bf16 v109, v17, v17
    s_cmp_eq_u32 s24, 1
    s_cbranch_scc1 L_sequ_t4_59
    v_pk_add_f32 v[152:153], v[152:153], v[104:105]
    v_pk_add_f32 v[154:155], v[154:155], v[106:107]
    s_waitcnt lgkmcnt(0)
    v_pk_add_f32 v[152:153], v[152:153], v[28:29]
    v_pk_add_f32 v[154:155], v[154:155], v[30:31]
    v_cvt_pk_bf16_f32 v18, v152, v153
    v_cvt_pk_bf16_f32 v19, v154, v155
    v_mov_b32 v84, v18
    v_mov_b32 v85, v19
    v_mov_b32 v80, v18
    v_mov_b32 v81, v19
    v_lshrrev_b32 v7, 1, v4
    v_lshlrev_b32 v7, 8, v7
    v_lshl_add_u32 v7, v3, 4, v7
    v_permlane16_swap_b32 v84, v82
    v_permlane16_swap_b32 v85, v83
    s_mov_b32 exec_lo, 0xffff
    s_mov_b32 exec_hi, 0xffff
    buffer_store_dwordx4 v[80:83], v7, s[4:7], s69 offen sc1
    s_mov_b64 exec, -1
    v_dot2c_f32_bf16 v108, v18, v110
    v_dot2c_f32_bf16 v109, v18, v18
    v_dot2c_f32_bf16 v108, v19, v110
    v_dot2c_f32_bf16 v109, v19, v19
L_sequ_t4_59:
    s_nop 2
    v_mov_b32 v5, v108
    v_mov_b32 v6, v109
    s_nop 0
    v_permlane16_swap_b32 v108, v5
    v_permlane16_swap_b32 v109, v6
    v_add_f32 v108, v108, v5
    v_add_f32 v109, v109, v6
    v_mov_b32 v5, v108
    v_mov_b32 v6, v109
    s_nop 0
    v_permlane32_swap_b32 v108, v5
    v_permlane32_swap_b32 v109, v6
    v_add_f32 v108, v108, v5
    v_add_f32 v109, v109, v6
    v_lshlrev_b32 v7, 3, v1
    s_mov_b64 exec, 0xffff
    buffer_store_dwordx2 v[108:109], v7, s[4:7], s70 offen sc1
    s_mov_b64 exec, -1
    v_mov_b32 v248, v2
    v_add_u32 v249, 50176, v2
    v_add_u32 v250, 100352, v2
    s_lshl_b32 s50, s80, 7
    s_add_u32 s50, s50, 22549504
    s_lshl_b32 s51, s27, 2
    s_add_u32 s51, s51, s50
    s_lshl_b32 s52, s80, 3
    s_add_u32 s52, s52, s20
    s_lshl_b32 s58, s52, 11
    s_add_u32 s58, s58, 22675456
    s_mul_i32 s52, s52, 20480
    s_add_u32 s52, s52, 5767168
    s_add_u32 s53, s52, 4096
    s_add_u32 s54, s52, 8192
    s_add_u32 s55, s52, 12288
    s_add_u32 s56, s52, 16384
    s_mul_i32 s67, s22, 276480
    s_add_u32 s67, s67, s66
    s_add_u32 s67, s67, 19922944
    ds_read_b128 v[128:131], v248 offset:0
    ds_read_b128 v[132:135], v248 offset:1024
    ds_read_b128 v[136:139], v248 offset:2048
    ds_read_b128 v[140:143], v248 offset:3072
    ds_read_b128 v[144:147], v248 offset:4096
    ds_read_b128 v[148:151], v248 offset:5120
    ds_read_b128 v[152:155], v248 offset:6144
    ds_read_b128 v[156:159], v248 offset:7168
    ds_read_b128 v[160:163], v248 offset:8192
    ds_read_b128 v[164:167], v248 offset:9216
    ds_read_b128 v[168:171], v248 offset:10240
    ds_read_b128 v[172:175], v248 offset:11264
    ds_read_b128 v[176:179], v248 offset:12288
    ds_read_b128 v[180:183], v248 offset:13312
    ds_read_b128 v[184:187], v248 offset:14336
    ds_read_b128 v[188:191], v248 offset:15360
    ds_read_b128 v[192:195], v248 offset:16384
    ds_read_b128 v[196:199], v248 offset:17408
    ds_read_b128 v[200:203], v248 offset:18432
    ds_read_b128 v[204:207], v248 offset:19456
    ds_read_b128 v[208:211], v248 offset:20480
    s_waitcnt vmcnt(0)
    s_waitcnt lgkmcnt(15)
    s_barrier
    s_cmp_lg_u32 s20, 0
    s_cbranch_scc1 L_sequ_w0_60
    v_mov_b32 v11, 0
    v_mov_b32 v12, s3
    s_mov_b64 exec, 1
    s_cmp_eq_u32 s35, 1
    s_cbranch_scc0 L_sequ_hs_61
    buffer_store_dword v12, v11, s[4:7], s51 offen
L_sequ_hb_62:
    s_mov_b64 exec, -1
L_sequ_w0_60:
    ds_read_b128 v[212:215], v248 offset:21504
    ds_read_b128 v[216:219], v248 offset:22528
    ds_read_b128 v[220:223], v248 offset:23552
    ds_read_b128 v[224:227], v248 offset:24576
    ds_read_b128 v[228:231], v248 offset:25600
    ds_read_b128 v[232:235], v248 offset:26624
    ds_read_b128 v[236:239], v248 offset:27648
    s_cmp_eq_u32 s20, 0
    s_cbranch_scc1 L_sequ_ct0_63
    s_lshl_b32 s57, s20, 7
    s_add_u32 s57, s57, 143232
    v_lshl_add_u32 v5, v3, 2, s57
    ds_write_b32 v5, v13
    ds_write_b32 v5, v0 offset:64
    s_branch L_sequ_ctj_64
L_sequ_ct0_63:
    v_lshlrev_b32 v11, 2, v1
    s_mov_b64 exec, 65535
    s_mov_b32 s78, 0
L_sequ_poll_65:
    buffer_load_dword v12, v11, s[4:7], s50 offen sc1
    s_add_u32 s78, s78, 1
    s_waitcnt vmcnt(0)
    v_cmp_ne_u32 vcc, s3, v12
    s_cmp_gt_u32 s78, 0x40000
    s_cbranch_scc1 L_sequ_polld_66
    s_cbranch_vccnz L_sequ_poll_65
L_sequ_polld_66:
    s_mov_b64 exec, -1
L_sequ_ctj_64:
    v_lshlrev_b32 v8, 9, v4
    v_lshl_add_u32 v8, v3, 3, v8
    v_lshlrev_b32 v5, 4, v4
    v_add_u32 v5, 143360, v5
    s_waitcnt lgkmcnt(0)
    s_barrier
    buffer_load_dwordx4 v[20:23], v2, s[4:7], s52 offen offset:0 sc1
    buffer_load_dwordx4 v[24:27], v2, s[4:7], s52 offen offset:1024 sc1
    buffer_load_dwordx4 v[28:31], v2, s[4:7], s52 offen offset:2048 sc1
    buffer_load_dwordx4 v[32:35], v2, s[4:7], s52 offen offset:3072 sc1
    s_waitcnt vmcnt(3)
    s_setprio 3
    v_mfma_f32_16x16x32_bf16 v[100:103], v[128:131], v[20:23], 0
    v_mfma_f32_16x16x32_bf16 v[104:107], v[132:135], v[20:23], 0
    v_mfma_f32_16x16x32_bf16 v[108:111], v[136:139], v[20:23], 0
    v_mfma_f32_16x16x32_bf16 v[112:115], v[140:143], v[20:23], 0
    v_mfma_f32_16x16x32_bf16 v[116:119], v[144:147], v[20:23], 0
    v_mfma_f32_16x16x32_bf16 v[120:123], v[148:151], v[20:23], 0
    v_mfma_f32_16x16x32_bf16 v[124:127], v[152:155], v[20:23], 0
    buffer_load_dwordx4 v[36:39], v2, s[4:7], s53 offen offset:0 sc1
    buffer_load_dwordx4 v[40:43], v2, s[4:7], s53 offen offset:1024 sc1
    s_waitcnt vmcnt(4)
    v_mfma_f32_16x16x32_bf16 v[100:103], v[156:159], v[24:27], v[100:103]
    ds_read_b128 v[128:131], v248 offset:28672
    v_mfma_f32_16x16x32_bf16 v[104:107], v[160:163], v[24:27], v[104:107]
    ds_read_b128 v[132:135], v248 offset:29696
    v_mfma_f32_16x16x32_bf16 v[108:111], v[164:167], v[24:27], v[108:111]
    ds_read_b128 v[136:139], v248 offset:30720
    v_mfma_f32_16x16x32_bf16 v[112:115], v[168:171], v[24:27], v[112:115]
    ds_read_b128 v[140:143], v248 offset:31744
    v_mfma_f32_16x16x32_bf16 v[116:119], v[172:175], v[24:27], v[116:119]
    ds_read_b128 v[144:147], v248 offset:32768
    v_mfma_f32_16x16x32_bf16 v[120:123], v[176:179], v[24:27], v[120:123]
    ds_read_b128 v[148:151], v248 offset:33792
    v_mfma_f32_16x16x32_bf16 v[124:127], v[180:183], v[24:27], v[124:127]
    ds_read_b128 v[152:155], v248 offset:34816
    buffer_load_dwordx4 v[44:47], v2, s[4:7], s53 offen offset:2048 sc1
    buffer_load_dwordx4 v[48:51], v2, s[4:7], s53 offen offset:3072 sc1
    s_waitcnt vmcnt(5)
    s_setprio 2
    v_mfma_f32_16x16x32_bf16 v[100:103], v[184:187], v[28:31], v[100:103]
    ds_read_b128 v[156:159], v248 offset:35840
    v_mfma_f32_16x16x32_bf16 v[104:107], v[188:191], v[28:31], v[104:107]
    ds_read_b128 v[160:163], v248 offset:36864
    v_mfma_f32_16x16x32_bf16 v[108:111], v[192:195], v[28:31], v[108:111]
    ds_read_b128 v[164:167], v248 offset:37888
    v_mfma_f32_16x16x32_bf16 v[112:115], v[196:199], v[28:31], v[112:115]
    ds_read_b128 v[168:171], v248 offset:38912
    v_mfma_f32_16x16x32_bf16 v[116:119], v[200:203], v[28:31], v[116:119]
    ds_read_b128 v[172:175], v248 offset:39936
    v_mfma_f32_16x16x32_bf16 v[120:123], v[204:207], v[28:31], v[120:123]
    ds_read_b128 v[176:179], v248 offset:40960
    v_mfma_f32_16x16x32_bf16 v[124:127], v[208:211], v[28:31], v[124:127]
    ds_read_b128 v[180:183], v248 offset:41984
    buffer_load_dwordx4 v[52:55], v2, s[4:7], s54 offen offset:0 sc1
    buffer_load_dwordx4 v[56:59], v2, s[4:7], s54 offen offset:1024 sc1
    s_waitcnt vmcnt(6)
    v_mfma_f32_16x16x32_bf16 v[100:103], v[212:215], v[32:35], v[100:103]
    ds_read_b128 v[184:187], v248 offset:43008
    v_mfma_f32_16x16x32_bf16 v[104:107], v[216:219], v[32:35], v[104:107]
    ds_read_b128 v[188:191], v248 offset:44032
    v_mfma_f32_16x16x32_bf16 v[108:111], v[220:223], v[32:35], v[108:111]
    ds_read_b128 v[192:195], v248 offset:45056
    v_mfma_f32_16x16x32_bf16 v[112:115], v[224:227], v[32:35], v[112:115]
    ds_read_b128 v[196:199], v248 offset:46080
    v_mfma_f32_16x16x32_bf16 v[116:119], v[228:231], v[32:35], v[116:119]
    ds_read_b128 v[200:203], v248 offset:47104
    v_mfma_f32_16x16x32_bf16 v[120:123], v[232:235], v[32:35], v[120:123]
    ds_read_b128 v[204:207], v248 offset:48128
    v_mfma_f32_16x16x32_bf16 v[124:127], v[236:239], v[32:35], v[124:127]
    ds_read_b128 v[208:211], v248 offset:49152
    buffer_load_dwordx4 v[60:63], v2, s[4:7], s54 offen offset:2048 sc1
    s_waitcnt vmcnt(6)
    buffer_load_dwordx4 v[64:67], v2, s[4:7], s54 offen offset:3072 sc1
    s_waitcnt vmcnt(7)
    s_waitcnt lgkmcnt(14)
    s_setprio 1
    v_mfma_f32_16x16x32_bf16 v[100:103], v[128:131], v[36:39], v[100:103]
    ds_read_b128 v[212:215], v249 offset:0
    v_mfma_f32_16x16x32_bf16 v[104:107], v[132:135], v[36:39], v[104:107]
    ds_read_b128 v[216:219], v249 offset:1024
    v_mfma_f32_16x16x32_bf16 v[108:111], v[136:139], v[36:39], v[108:111]
    ds_read_b128 v[220:223], v249 offset:2048
    v_mfma_f32_16x16x32_bf16 v[112:115], v[140:143], v[36:39], v[112:115]
    ds_read_b128 v[224:227], v249 offset:3072
    v_mfma_f32_16x16x32_bf16 v[116:119], v[144:147], v[36:39], v[116:119]
    ds_read_b128 v[228:231], v249 offset:4096
    v_mfma_f32_16x16x32_bf16 v[120:123], v[148:151], v[36:39], v[120:123]
    ds_read_b128 v[232:235], v249 offset:5120
    v_mfma_f32_16x16x32_bf16 v[124:127], v[152:155], v[36:39], v[124:127]
    ds_read_b128 v[236:239], v249 offset:6144
    s_waitcnt vmcnt(6)
    buffer_load_dwordx4 v[68:71], v2, s[4:7], s55 offen offset:0 sc1
    s_waitcnt vmcnt(6)
    buffer_load_dwordx4 v[72:75], v2, s[4:7], s55 offen offset:1024 sc1
    s_waitcnt vmcnt(8)
    s_waitcnt lgkmcnt(14)
    v_mfma_f32_16x16x32_bf16 v[100:103], v[156:159], v[40:43], v[100:103]
    ds_read_b128 v[128:131], v249 offset:7168
    v_mfma_f32_16x16x32_bf16 v[104:107], v[160:163], v[40:43], v[104:107]
    ds_read_b128 v[132:135], v249 offset:8192
    v_mfma_f32_16x16x32_bf16 v[108:111], v[164:167], v[40:43], v[108:111]
    ds_read_b128 v[136:139], v249 offset:9216
    v_mfma_f32_16x16x32_bf16 v[112:115], v[168:171], v[40:43], v[112:115]
    ds_read_b128 v[140:143], v249 offset:10240
    v_mfma_f32_16x16x32_bf16 v[116:119], v[172:175], v[40:43], v[116:119]
    ds_read_b128 v[144:147], v249 offset:11264
    v_mfma_f32_16x16x32_bf16 v[120:123], v[176:179], v[40:43], v[120:123]
    ds_read_b128 v[148:151], v249 offset:12288
    v_mfma_f32_16x16x32_bf16 v[124:127], v[180:183], v[40:43], v[124:127]
    ds_read_b128 v[152:155], v249 offset:13312
    s_waitcnt vmcnt(6)
    buffer_load_dwordx4 v[76:79], v2, s[4:7], s55 offen offset:2048 sc1
    s_waitcnt vmcnt(6)
    buffer_load_dwordx4 v[80:83], v2, s[4:7], s55 offen offset:3072 sc1
    s_waitcnt vmcnt(9)
    s_waitcnt lgkmcnt(14)
    s_setprio 0
    v_mfma_f32_16x16x32_bf16 v[100:103], v[184:187], v[44:47], v[100:103]
    ds_read_b128 v[156:159], v249 offset:14336
    v_mfma_f32_16x16x32_bf16 v[104:107], v[188:191], v[44:47], v[104:107]
    ds_read_b128 v[160:163], v249 offset:15360
    v_mfma_f32_16x16x32_bf16 v[108:111], v[192:195], v[44:47], v[108:111]
    ds_read_b128 v[164:167], v249 offset:16384
    v_mfma_f32_16x16x32_bf16 v[112:115], v[196:199], v[44:47], v[112:115]
    ds_read_b128 v[168:171], v249 offset:17408
    v_mfma_f32_16x16x32_bf16 v[116:119], v[200:203], v[44:47], v[116:119]
    ds_read_b128 v[172:175], v249 offset:18432
    v_mfma_f32_16x16x32_bf16 v[120:123], v[204:207], v[44:47], v[120:123]
    ds_read_b128 v[176:179], v249 offset:19456
    v_mfma_f32_16x16x32_bf16 v[124:127], v[208:211], v[44:47], v[124:127]
    ds_read_b128 v[180:183], v249 offset:20480
    s_waitcnt vmcnt(6)
    buffer_load_dwordx4 v[84:87], v2, s[4:7], s56 offen offset:0 sc1
    s_waitcnt vmcnt(6)
    buffer_load_dwordx4 v[88:91], v2, s[4:7], s56 offen offset:1024 sc1
    s_waitcnt vmcnt(10)
    s_waitcnt lgkmcnt(14)
    v_mfma_f32_16x16x32_bf16 v[100:103], v[212:215], v[48:51], v[100:103]
    ds_read_b128 v[184:187], v249 offset:21504
    v_mfma_f32_16x16x32_bf16 v[104:107], v[216:219], v[48:51], v[104:107]
    ds_read_b128 v[188:191], v249 offset:22528
    v_mfma_f32_16x16x32_bf16 v[108:111], v[220:223], v[48:51], v[108:111]
    ds_read_b128 v[192:195], v249 offset:23552
    v_mfma_f32_16x16x32_bf16 v[112:115], v[224:227], v[48:51], v[112:115]
    ds_read_b128 v[196:199], v249 offset:24576
    v_mfma_f32_16x16x32_bf16 v[116:119], v[228:231], v[48:51], v[116:119]
    ds_read_b128 v[200:203], v249 offset:25600
    v_mfma_f32_16x16x32_bf16 v[120:123], v[232:235], v[48:51], v[120:123]
    ds_read_b128 v[204:207], v249 offset:26624
    v_mfma_f32_16x16x32_bf16 v[124:127], v[236:239], v[48:51], v[124:127]
    ds_read_b128 v[208:211], v249 offset:27648
    s_waitcnt vmcnt(6)
    buffer_load_dwordx4 v[92:95], v2, s[4:7], s56 offen offset:2048 sc1
    s_waitcnt vmcnt(6)
    buffer_load_dwordx4 v[96:99], v2, s[4:7], s56 offen offset:3072 sc1
    s_waitcnt vmcnt(11)
    s_waitcnt lgkmcnt(0)
    s_barrier
    s_setprio 3
    v_mfma_f32_16x16x32_bf16 v[100:103], v[128:131], v[52:55], v[100:103]
    ds_read_b128 v[212:215], v249 offset:28672
    v_mfma_f32_16x16x32_bf16 v[104:107], v[132:135], v[52:55], v[104:107]
    ds_read_b128 v[216:219], v249 offset:29696
    v_mfma_f32_16x16x32_bf16 v[108:111], v[136:139], v[52:55], v[108:111]
    ds_read_b128 v[220:223], v249 offset:30720
    v_mfma_f32_16x16x32_bf16 v[112:115], v[140:143], v[52:55], v[112:115]
    ds_read_b128 v[224:227], v249 offset:31744
    v_mfma_f32_16x16x32_bf16 v[116:119], v[144:147], v[52:55], v[116:119]
    ds_read_b128 v[228:231], v249 offset:32768
    v_mfma_f32_16x16x32_bf16 v[120:123], v[148:151], v[52:55], v[120:123]
    ds_read_b128 v[232:235], v249 offset:33792
    v_mfma_f32_16x16x32_bf16 v[124:127], v[152:155], v[52:55], v[124:127]
    ds_read_b128 v[236:239], v249 offset:34816
    s_waitcnt vmcnt(6)
    buffer_load_dwordx2 v[240:241], v8, s[4:7], s58 offen offset:0 sc1
    s_waitcnt vmcnt(6)
    buffer_load_dwordx2 v[242:243], v8, s[4:7], s58 offen offset:128 sc1
    s_waitcnt vmcnt(12)
    s_waitcnt lgkmcnt(14)
    v_mfma_f32_16x16x32_bf16 v[100:103], v[156:159], v[56:59], v[100:103]
    ds_read_b128 v[128:131], v249 offset:35840
    v_mfma_f32_16x16x32_bf16 v[104:107], v[160:163], v[56:59], v[104:107]
    ds_read_b128 v[132:135], v249 offset:36864
    v_mfma_f32_16x16x32_bf16 v[108:111], v[164:167], v[56:59], v[108:111]
    ds_read_b128 v[136:139], v249 offset:37888
    v_mfma_f32_16x16x32_bf16 v[112:115], v[168:171], v[56:59], v[112:115]
    ds_read_b128 v[140:143], v249 offset:38912
    v_mfma_f32_16x16x32_bf16 v[116:119], v[172:175], v[56:59], v[116:119]
    ds_read_b128 v[144:147], v249 offset:39936
    v_mfma_f32_16x16x32_bf16 v[120:123], v[176:179], v[56:59], v[120:123]
    ds_read_b128 v[148:151], v249 offset:40960
    v_mfma_f32_16x16x32_bf16 v[124:127], v[180:183], v[56:59], v[124:127]
    ds_read_b128 v[152:155], v249 offset:41984
    s_waitcnt vmcnt(6)
    buffer_load_dwordx2 v[244:245], v8, s[4:7], s58 offen offset:256 sc1
    s_waitcnt vmcnt(6)
    buffer_load_dwordx2 v[246:247], v8, s[4:7], s58 offen offset:384 sc1
    s_waitcnt vmcnt(13)
    s_waitcnt lgkmcnt(14)
    s_setprio 2
    v_mfma_f32_16x16x32_bf16 v[100:103], v[184:187], v[60:63], v[100:103]
    ds_read_b128 v[156:159], v249 offset:43008
    v_mfma_f32_16x16x32_bf16 v[104:107], v[188:191], v[60:63], v[104:107]
    ds_read_b128 v[160:163], v249 offset:44032
    v_mfma_f32_16x16x32_bf16 v[108:111], v[192:195], v[60:63], v[108:111]
    ds_read_b128 v[164:167], v249 offset:45056
    v_mfma_f32_16x16x32_bf16 v[112:115], v[196:199], v[60:63], v[112:115]
    ds_read_b128 v[168:171], v249 offset:46080
    v_mfma_f32_16x16x32_bf16 v[116:119], v[200:203], v[60:63], v[116:119]
    ds_read_b128 v[172:175], v249 offset:47104
    v_mfma_f32_16x16x32_bf16 v[120:123], v[204:207], v[60:63], v[120:123]
    ds_read_b128 v[176:179], v249 offset:48128
    v_mfma_f32_16x16x32_bf16 v[124:127], v[208:211], v[60:63], v[124:127]
    ds_read_b128 v[180:183], v249 offset:49152
    s_add_u32 m0, s66, 0
    s_add_u32 s65, s67, 0
    s_waitcnt vmcnt(6)
    buffer_load_dwordx4 v2, s[4:7], s65 offen sc1 lds
    s_add_u32 m0, s66, 8192
    s_add_u32 s65, s67, 8192
    s_waitcnt vmcnt(6)
    buffer_load_dwordx4 v2, s[4:7], s65 offen sc1 lds
    s_waitcnt vmcnt(14)
    s_waitcnt lgkmcnt(14)
    s_setprio 1
    v_mfma_f32_16x16x32_bf16 v[100:103], v[212:215], v[64:67], v[100:103]
    ds_read_b128 v[184:187], v250 offset:0
    v_mfma_f32_16x16x32_bf16 v[104:107], v[216:219], v[64:67], v[104:107]
    ds_read_b128 v[188:191], v250 offset:1024
    v_mfma_f32_16x16x32_bf16 v[108:111], v[220:223], v[64:67], v[108:111]
    ds_read_b128 v[192:195], v250 offset:2048
    v_mfma_f32_16x16x32_bf16 v[112:115], v[224:227], v[64:67], v[112:115]
    ds_read_b128 v[196:199], v250 offset:3072
    v_mfma_f32_16x16x32_bf16 v[116:119], v[228:231], v[64:67], v[116:119]
    ds_read_b128 v[200:203], v250 offset:4096
    v_mfma_f32_16x16x32_bf16 v[120:123], v[232:235], v[64:67], v[120:123]
    ds_read_b128 v[204:207], v250 offset:5120
    v_mfma_f32_16x16x32_bf16 v[124:127], v[236:239], v[64:67], v[124:127]
    ds_read_b128 v[208:211], v250 offset:6144
    s_add_u32 m0, s66, 16384
    s_add_u32 s65, s67, 16384
    s_waitcnt vmcnt(6)
    buffer_load_dwordx4 v2, s[4:7], s65 offen sc1 lds
    s_add_u32 m0, s66, 24576
    s_add_u32 s65, s67, 24576
    s_waitcnt vmcnt(6)
    buffer_load_dwordx4 v2, s[4:7], s65 offen sc1 lds
    s_waitcnt vmcnt(15)
    s_waitcnt lgkmcnt(14)
    v_mfma_f32_16x16x32_bf16 v[100:103], v[128:131], v[68:71], v[100:103]
    ds_read_b128 v[212:215], v250 offset:7168
    v_mfma_f32_16x16x32_bf16 v[104:107], v[132:135], v[68:71], v[104:107]
    ds_read_b128 v[216:219], v250 offset:8192
    v_mfma_f32_16x16x32_bf16 v[108:111], v[136:139], v[68:71], v[108:111]
    ds_read_b128 v[220:223], v250 offset:9216
    v_mfma_f32_16x16x32_bf16 v[112:115], v[140:143], v[68:71], v[112:115]
    ds_read_b128 v[224:227], v250 offset:10240
    v_mfma_f32_16x16x32_bf16 v[116:119], v[144:147], v[68:71], v[116:119]
    ds_read_b128 v[228:231], v250 offset:11264
    v_mfma_f32_16x16x32_bf16 v[120:123], v[148:151], v[68:71], v[120:123]
    ds_read_b128 v[232:235], v250 offset:12288
    v_mfma_f32_16x16x32_bf16 v[124:127], v[152:155], v[68:71], v[124:127]
    ds_read_b128 v[236:239], v250 offset:13312
    s_add_u32 m0, s66, 32768
    s_add_u32 s65, s67, 32768
    s_waitcnt vmcnt(6)
    buffer_load_dwordx4 v2, s[4:7], s65 offen sc1 lds
    s_add_u32 m0, s66, 40960
    s_add_u32 s65, s67, 40960
    s_waitcnt vmcnt(6)
    buffer_load_dwordx4 v2, s[4:7], s65 offen sc1 lds
    s_waitcnt vmcnt(16)
    s_waitcnt lgkmcnt(14)
    s_setprio 0
    v_mfma_f32_16x16x32_bf16 v[100:103], v[156:159], v[72:75], v[100:103]
    ds_read_b128 v[128:131], v250 offset:14336
    v_mfma_f32_16x16x32_bf16 v[104:107], v[160:163], v[72:75], v[104:107]
    ds_read_b128 v[132:135], v250 offset:15360
    v_mfma_f32_16x16x32_bf16 v[108:111], v[164:167], v[72:75], v[108:111]
    ds_read_b128 v[136:139], v250 offset:16384
    v_mfma_f32_16x16x32_bf16 v[112:115], v[168:171], v[72:75], v[112:115]
    ds_read_b128 v[140:143], v250 offset:17408
    v_mfma_f32_16x16x32_bf16 v[116:119], v[172:175], v[72:75], v[116:119]
    ds_read_b128 v[144:147], v250 offset:18432
    v_mfma_f32_16x16x32_bf16 v[120:123], v[176:179], v[72:75], v[120:123]
    ds_read_b128 v[148:151], v250 offset:19456
    v_mfma_f32_16x16x32_bf16 v[124:127], v[180:183], v[72:75], v[124:127]
    ds_read_b128 v[152:155], v250 offset:20480
    s_add_u32 m0, s66, 49152
    s_add_u32 s65, s67, 49152
    s_waitcnt vmcnt(6)
    buffer_load_dwordx4 v2, s[4:7], s65 offen sc1 lds
    s_add_u32 m0, s66, 57344
    s_add_u32 s65, s67, 57344
    s_waitcnt vmcnt(6)
    buffer_load_dwordx4 v2, s[4:7], s65 offen sc1 lds
    s_waitcnt vmcnt(17)
    s_waitcnt lgkmcnt(0)
    s_barrier
    s_setprio 3
    v_mfma_f32_16x16x32_bf16 v[100:103], v[184:187], v[76:79], v[100:103]
    ds_read_b128 v[156:159], v250 offset:21504
    s_waitcnt vmcnt(8)
    v_mfma_f32_16x16x32_bf16 v[104:107], v[188:191], v[76:79], v[104:107]
    ds_read_b128 v[160:163], v250 offset:22528
    v_add_f32 v240, v240, v242
    v_mfma_f32_16x16x32_bf16 v[108:111], v[192:195], v[76:79], v[108:111]
    ds_read_b128 v[164:167], v250 offset:23552
    v_add_f32 v244, v244, v246
    v_mfma_f32_16x16x32_bf16 v[112:115], v[196:199], v[76:79], v[112:115]
    ds_read_b128 v[168:171], v250 offset:24576
    v_add_f32 v241, v241, v243
    v_mfma_f32_16x16x32_bf16 v[116:119], v[200:203], v[76:79], v[116:119]
    ds_read_b128 v[172:175], v250 offset:25600
    v_add_f32 v245, v245, v247
    v_mfma_f32_16x16x32_bf16 v[120:123], v[204:207], v[76:79], v[120:123]
    ds_read_b128 v[176:179], v250 offset:26624
    v_add_f32 v240, v240, v244
    v_mfma_f32_16x16x32_bf16 v[124:127], v[208:211], v[76:79], v[124:127]
    ds_read_b128 v[180:183], v250 offset:27648
    v_add_f32 v241, v241, v245
    s_add_u32 m0, s66, 65536
    s_add_u32 s65, s67, 65536
    s_waitcnt vmcnt(6)
    buffer_load_dwordx4 v2, s[4:7], s65 offen sc1 lds
    s_add_u32 m0, s66, 73728
    s_add_u32 s65, s67, 73728
    s_waitcnt vmcnt(6)
    buffer_load_dwordx4 v2, s[4:7], s65 offen sc1 lds
    s_waitcnt vmcnt(18)
    s_waitcnt lgkmcnt(14)
    v_mfma_f32_16x16x32_bf16 v[100:103], v[212:215], v[80:83], v[100:103]
    ds_read_b128 v[184:187], v250 offset:28672
    v_mov_b32 v6, v240
    v_mfma_f32_16x16x32_bf16 v[104:107], v[216:219], v[80:83], v[104:107]
    ds_read_b128 v[188:191], v250 offset:29696
    v_mov_b32 v7, v241
    v_mfma_f32_16x16x32_bf16 v[108:111], v[220:223], v[80:83], v[108:111]
    ds_read_b128 v[192:195], v250 offset:30720
    v_permlane16_swap_b32 v240, v6
    v_mfma_f32_16x16x32_bf16 v[112:115], v[224:227], v[80:83], v[112:115]
    ds_read_b128 v[196:199], v250 offset:31744
    v_permlane16_swap_b32 v241, v7
    v_mfma_f32_16x16x32_bf16 v[116:119], v[228:231], v[80:83], v[116:119]
    ds_read_b128 v[200:203], v250 offset:32768
    v_add_f32 v240, v240, v6
    v_mfma_f32_16x16x32_bf16 v[120:123], v[232:235], v[80:83], v[120:123]
    ds_read_b128 v[204:207], v250 offset:33792
    v_add_f32 v241, v241, v7
    v_mfma_f32_16x16x32_bf16 v[124:127], v[236:239], v[80:83], v[124:127]
    ds_read_b128 v[208:211], v250 offset:34816
    v_mov_b32 v6, v240
    s_add_u32 m0, s66, 81920
    s_add_u32 s65, s67, 81920
    s_waitcnt vmcnt(6)
    buffer_load_dwordx4 v2, s[4:7], s65 offen sc1 lds
    s_add_u32 m0, s66, 90112
    s_add_u32 s65, s67, 90112
    s_waitcnt vmcnt(6)
    buffer_load_dwordx4 v2, s[4:7], s65 offen sc1 lds
    s_waitcnt vmcnt(19)
    s_waitcnt lgkmcnt(14)
    s_setprio 2
    v_mfma_f32_16x16x32_bf16 v[100:103], v[128:131], v[84:87], v[100:103]
    ds_read_b128 v[212:215], v250 offset:35840
    v_mov_b32 v7, v241
    v_mfma_f32_16x16x32_bf16 v[104:107], v[132:135], v[84:87], v[104:107]
    ds_read_b128 v[216:219], v250 offset:36864
    v_permlane32_swap_b32 v240, v6
    v_mfma_f32_16x16x32_bf16 v[108:111], v[136:139], v[84:87], v[108:111]
    ds_read_b128 v[220:223], v250 offset:37888
    v_permlane32_swap_b32 v241, v7
    v_mfma_f32_16x16x32_bf16 v[112:115], v[140:143], v[84:87], v[112:115]
    ds_read_b128 v[224:227], v250 offset:38912
    v_add_f32 v240, v240, v6
    v_mfma_f32_16x16x32_bf16 v[116:119], v[144:147], v[84:87], v[116:119]
    ds_read_b128 v[228:231], v250 offset:39936
    v_add_f32 v241, v241, v7
    v_mfma_f32_16x16x32_bf16 v[120:123], v[148:151], v[84:87], v[120:123]
    ds_read_b128 v[232:235], v250 offset:40960
    v_mul_f32 v242, 0x3acccccd, v240
    v_mfma_f32_16x16x32_bf16 v[124:127], v[152:155], v[84:87], v[124:127]
    ds_read_b128 v[236:239], v250 offset:41984
    v_mul_f32 v241, 0x3acccccd, v241
    s_add_u32 m0, s66, 98304
    s_add_u32 s65, s67, 98304
    s_waitcnt vmcnt(6)
    buffer_load_dwordx4 v2, s[4:7], s65 offen sc1 lds
    s_add_u32 m0, s66, 106496
    s_add_u32 s65, s67, 106496
    s_waitcnt vmcnt(6)
    buffer_load_dwordx4 v2, s[4:7], s65 offen sc1 lds
    s_waitcnt vmcnt(20)
    s_waitcnt lgkmcnt(14)
    s_setprio 1
    v_mfma_f32_16x16x32_bf16 v[100:103], v[156:159], v[88:91], v[100:103]
    v_fma_f32 v241, -v242, v242, v241
    ds_read_b128 v[20:23], v5 offset:0
    v_mfma_f32_16x16x32_bf16 v[104:107], v[160:163], v[88:91], v[104:107]
    v_max_f32 v241, 0, v241
    ds_read_b128 v[24:27], v5 offset:128
    v_mfma_f32_16x16x32_bf16 v[108:111], v[164:167], v[88:91], v[108:111]
    v_add_f32 v240, 0x3727c5ac, v241
    ds_read_b128 v[28:31], v5 offset:256
    v_mfma_f32_16x16x32_bf16 v[112:115], v[168:171], v[88:91], v[112:115]
    v_rsq_f32 v6, v240
    ds_read_b128 v[32:35], v5 offset:384
    v_mfma_f32_16x16x32_bf16 v[116:119], v[172:175], v[88:91], v[116:119]
    v_mul_f32 v240, v6, v6
    ds_read_b128 v[36:39], v5 offset:512
    v_mfma_f32_16x16x32_bf16 v[120:123], v[176:179], v[88:91], v[120:123]
    v_mul_f32 v240, v240, v241
    ds_read_b128 v[40:43], v5 offset:640
    v_mfma_f32_16x16x32_bf16 v[124:127], v[180:183], v[88:91], v[124:127]
    v_add_f32 v240, 0x3727c5ac, v240
    ds_read_b128 v[44:47], v5 offset:768
    s_waitcnt vmcnt(19)
    s_waitcnt lgkmcnt(14)
    v_mfma_f32_16x16x32_bf16 v[100:103], v[184:187], v[92:95], v[100:103]
    v_rsq_f32 v240, v240
    ds_read_b128 v[48:51], v5 offset:64
    v_mfma_f32_16x16x32_bf16 v[104:107], v[188:191], v[92:95], v[104:107]
    v_mul_f32 v6, v6, v240
    ds_read_b128 v[52:55], v5 offset:192
    v_mfma_f32_16x16x32_bf16 v[108:111], v[192:195], v[92:95], v[108:111]
    v_rcp_f32 v244, v6
    ds_read_b128 v[56:59], v5 offset:320
    v_mfma_f32_16x16x32_bf16 v[112:115], v[196:199], v[92:95], v[112:115]
    v_mul_f32 v252, 0xc0135761, v6
    ds_read_b128 v[60:63], v5 offset:448
    v_mfma_f32_16x16x32_bf16 v[116:119], v[200:203], v[92:95], v[116:119]
    v_mul_f32 v246, v6, v6
    ds_read_b128 v[64:67], v5 offset:576
    v_mfma_f32_16x16x32_bf16 v[120:123], v[204:207], v[92:95], v[120:123]
    v_mul_f32 v246, v246, v6
    ds_read_b128 v[68:71], v5 offset:704
    v_mfma_f32_16x16x32_bf16 v[124:127], v[208:211], v[92:95], v[124:127]
    v_mul_f32 v246, 0xbdd2d3e8, v246
    ds_read_b128 v[72:75], v5 offset:832
    s_waitcnt vmcnt(18)
    s_waitcnt lgkmcnt(14)
    s_setprio 0
    v_mfma_f32_16x16x32_bf16 v[100:103], v[212:215], v[96:99], v[100:103]
    v_mfma_f32_16x16x32_bf16 v[104:107], v[216:219], v[96:99], v[104:107]
    v_mfma_f32_16x16x32_bf16 v[108:111], v[220:223], v[96:99], v[108:111]
    v_mfma_f32_16x16x32_bf16 v[112:115], v[224:227], v[96:99], v[112:115]
    v_mfma_f32_16x16x32_bf16 v[116:119], v[228:231], v[96:99], v[116:119]
    v_mfma_f32_16x16x32_bf16 v[120:123], v[232:235], v[96:99], v[120:123]
    v_mfma_f32_16x16x32_bf16 v[124:127], v[236:239], v[96:99], v[124:127]
    s_mov_b32 s16, s42
    s_mov_b32 s17, s43
    s_mov_b32 s18, 1280
    s_mov_b32 s19, 0x00020000
    v_lshlrev_b32 v9, 5, v1
    s_waitcnt vmcnt(6)
    buffer_load_dword v9, v9, s[16:19], 0 offen
    s_setprio 0
    s_mul_i32 s52, s24, 5120
    v_add_u32 v254, s52, v2
    v_add_u32 v255, 61440, v254
    v_add_u32 v13, 122880, v254
    s_waitcnt vmcnt(5)
    s_waitcnt lgkmcnt(0)
    s_barrier
    s_setprio 3
    v_pk_fma_f32 v[100:101], v[20:21], v[242:243], v[100:101] op_sel_hi:[1,0,1] neg_lo:[1,0,0] neg_hi:[1,0,0]
    v_pk_fma_f32 v[102:103], v[22:23], v[242:243], v[102:103] op_sel_hi:[1,0,1] neg_lo:[1,0,0] neg_hi:[1,0,0]
    v_pk_fma_f32 v[104:105], v[24:25], v[242:243], v[104:105] op_sel_hi:[1,0,1] neg_lo:[1,0,0] neg_hi:[1,0,0]
    v_pk_fma_f32 v[106:107], v[26:27], v[242:243], v[106:107] op_sel_hi:[1,0,1] neg_lo:[1,0,0] neg_hi:[1,0,0]
    ds_read_b128 v[128:131], v254 offset:0
    ds_read_b128 v[132:135], v254 offset:1024
    ds_read_b128 v[136:139], v254 offset:2048
    s_add_u32 m0, s66, 114688
    s_add_u32 s65, s67, 114688
    buffer_load_dwordx4 v2, s[4:7], s65 offen sc1 lds
    v_pk_fma_f32 v[100:101], v[48:49], v[244:245], v[100:101] op_sel_hi:[1,0,1]
    v_pk_fma_f32 v[102:103], v[50:51], v[244:245], v[102:103] op_sel_hi:[1,0,1]
    v_pk_fma_f32 v[104:105], v[52:53], v[244:245], v[104:105] op_sel_hi:[1,0,1]
    v_pk_fma_f32 v[106:107], v[54:55], v[244:245], v[106:107] op_sel_hi:[1,0,1]
    ds_read_b128 v[140:143], v254 offset:3072
    ds_read_b128 v[144:147], v254 offset:4096
    ds_read_b128 v[148:151], v254 offset:10240
    s_add_u32 m0, s66, 122880
    s_add_u32 s65, s67, 122880
    buffer_load_dwordx4 v2, s[4:7], s65 offen sc1 lds
    v_pk_mul_f32 v[48:49], v[100:101], v[100:101]
    v_pk_mul_f32 v[50:51], v[102:103], v[102:103]
    v_pk_mul_f32 v[52:53], v[104:105], v[104:105]
    v_pk_mul_f32 v[54:55], v[106:107], v[106:107]
    ds_read_b128 v[152:155], v254 offset:11264
    ds_read_b128 v[156:159], v254 offset:12288
    ds_read_b128 v[160:163], v254 offset:13312
    s_add_u32 m0, s66, 131072
    s_add_u32 s65, s67, 131072
    buffer_load_dwordx4 v2, s[4:7], s65 offen sc1 lds
    v_pk_fma_f32 v[48:49], v[48:49], v[246:247], v[252:253] op_sel_hi:[1,0,0]
    v_pk_fma_f32 v[50:51], v[50:51], v[246:247], v[252:253] op_sel_hi:[1,0,0]
    v_pk_fma_f32 v[52:53], v[52:53], v[246:247], v[252:253] op_sel_hi:[1,0,0]
    v_pk_fma_f32 v[54:55], v[54:55], v[246:247], v[252:253] op_sel_hi:[1,0,0]
    ds_read_b128 v[164:167], v254 offset:14336
    ds_read_b128 v[168:171], v254 offset:20480
    ds_read_b128 v[172:175], v254 offset:21504
    s_add_u32 m0, s66, 139264
    s_add_u32 s65, s67, 139264
    buffer_load_dwordx4 v2, s[4:7], s65 offen sc1 lds
    v_pk_mul_f32 v[48:49], v[48:49], v[100:101]
    v_pk_mul_f32 v[50:51], v[50:51], v[102:103]
    v_pk_mul_f32 v[52:53], v[52:53], v[104:105]
    v_pk_mul_f32 v[54:55], v[54:55], v[106:107]
    ds_read_b128 v[176:179], v254 offset:22528
    ds_read_b128 v[180:183], v254 offset:23552
    ds_read_b128 v[184:187], v254 offset:24576
    s_add_u32 m0, s66, 147456
    s_add_u32 s65, s67, 147456
    buffer_load_dwordx4 v2, s[4:7], s65 offen sc1 lds
    v_exp_f32 v48, v48
    v_exp_f32 v49, v49
    v_exp_f32 v50, v50
    v_exp_f32 v51, v51
    v_exp_f32 v52, v52
    v_exp_f32 v53, v53
    v_exp_f32 v54, v54
    v_exp_f32 v55, v55
    ds_read_b128 v[188:191], v254 offset:30720
    ds_read_b128 v[192:195], v254 offset:31744
    ds_read_b128 v[196:199], v254 offset:32768
    s_add_u32 m0, s66, 155648
    s_add_u32 s65, s67, 155648
    buffer_load_dwordx4 v2, s[4:7], s65 offen sc1 lds
    v_pk_fma_f32 v[48:49], v[48:49], v[244:245], v[244:245] op_sel_hi:[1,0,0]
    v_pk_fma_f32 v[50:51], v[50:51], v[244:245], v[244:245] op_sel_hi:[1,0,0]
    v_pk_fma_f32 v[52:53], v[52:53], v[244:245], v[244:245] op_sel_hi:[1,0,0]
    v_pk_fma_f32 v[54:55], v[54:55], v[244:245], v[244:245] op_sel_hi:[1,0,0]
    ds_read_b128 v[200:203], v254 offset:33792
    ds_read_b128 v[204:207], v254 offset:34816
    ds_read_b128 v[208:211], v254 offset:40960
    ds_read_b128 v[212:215], v254 offset:41984
    v_rcp_f32 v48, v48
    v_rcp_f32 v49, v49
    v_rcp_f32 v50, v50
    v_rcp_f32 v51, v51
    v_rcp_f32 v52, v52
    v_rcp_f32 v53, v53
    v_rcp_f32 v54, v54
    v_rcp_f32 v55, v55
    ds_read_b128 v[216:219], v254 offset:43008
    ds_read_b128 v[220:223], v254 offset:44032
    ds_read_b128 v[224:227], v254 offset:45056
    v_pk_mul_f32 v[100:101], v[100:101], v[48:49]
    v_pk_mul_f32 v[102:103], v[102:103], v[50:51]
    v_pk_mul_f32 v[104:105], v[104:105], v[52:53]
    v_pk_mul_f32 v[106:107], v[106:107], v[54:55]
    v_cvt_pk_bf16_f32 v76, v100, v101
    v_cvt_pk_bf16_f32 v77, v102, v103
    v_cvt_pk_bf16_f32 v78, v104, v105
    v_cvt_pk_bf16_f32 v79, v106, v107
    buffer_store_dwordx4 v[76:79], v2, s[4:7], s71 offen offset:0 sc1
    s_waitcnt lgkmcnt(0)
    s_barrier
    s_setprio 2
    v_pk_fma_f32 v[108:109], v[28:29], v[242:243], v[108:109] op_sel_hi:[1,0,1] neg_lo:[1,0,0] neg_hi:[1,0,0]
    v_pk_fma_f32 v[110:111], v[30:31], v[242:243], v[110:111] op_sel_hi:[1,0,1] neg_lo:[1,0,0] neg_hi:[1,0,0]
    v_pk_fma_f32 v[112:113], v[32:33], v[242:243], v[112:113] op_sel_hi:[1,0,1] neg_lo:[1,0,0] neg_hi:[1,0,0]
    v_pk_fma_f32 v[114:115], v[34:35], v[242:243], v[114:115] op_sel_hi:[1,0,1] neg_lo:[1,0,0] neg_hi:[1,0,0]
    s_add_u32 m0, s66, 0
    s_add_u32 s65, s67, 163840
    buffer_load_dwordx4 v2, s[4:7], s65 offen sc1 lds
    v_pk_fma_f32 v[108:109], v[56:57], v[244:245], v[108:109] op_sel_hi:[1,0,1]
    v_pk_fma_f32 v[110:111], v[58:59], v[244:245], v[110:111] op_sel_hi:[1,0,1]
    v_pk_fma_f32 v[112:113], v[60:61], v[244:245], v[112:113] op_sel_hi:[1,0,1]
    v_pk_fma_f32 v[114:115], v[62:63], v[244:245], v[114:115] op_sel_hi:[1,0,1]
    s_add_u32 m0, s66, 8192
    s_add_u32 s65, s67, 172032
    buffer_load_dwordx4 v2, s[4:7], s65 offen sc1 lds
    v_pk_mul_f32 v[56:57], v[108:109], v[108:109]
    v_pk_mul_f32 v[58:59], v[110:111], v[110:111]
    v_pk_mul_f32 v[60:61], v[112:113], v[112:113]
    v_pk_mul_f32 v[62:63], v[114:115], v[114:115]
    s_add_u32 m0, s66, 16384
    s_add_u32 s65, s67, 180224
    buffer_load_dwordx4 v2, s[4:7], s65 offen sc1 lds
    v_pk_fma_f32 v[56:57], v[56:57], v[246:247], v[252:253] op_sel_hi:[1,0,0]
    v_pk_fma_f32 v[58:59], v[58:59], v[246:247], v[252:253] op_sel_hi:[1,0,0]
    v_pk_fma_f32 v[60:61], v[60:61], v[246:247], v[252:253] op_sel_hi:[1,0,0]
    v_pk_fma_f32 v[62:63], v[62:63], v[246:247], v[252:253] op_sel_hi:[1,0,0]
    v_pk_mul_f32 v[56:57], v[56:57], v[108:109]
    v_pk_mul_f32 v[58:59], v[58:59], v[110:111]
    v_pk_mul_f32 v[60:61], v[60:61], v[112:113]
    v_pk_mul_f32 v[62:63], v[62:63], v[114:115]
    v_exp_f32 v56, v56
    v_exp_f32 v57, v57
    v_exp_f32 v58, v58
    v_exp_f32 v59, v59
    v_exp_f32 v60, v60
    v_exp_f32 v61, v61
    v_exp_f32 v62, v62
    v_exp_f32 v63, v63
    v_pk_fma_f32 v[56:57], v[56:57], v[244:245], v[244:245] op_sel_hi:[1,0,0]
    v_pk_fma_f32 v[58:59], v[58:59], v[244:245], v[244:245] op_sel_hi:[1,0,0]
    v_pk_fma_f32 v[60:61], v[60:61], v[244:245], v[244:245] op_sel_hi:[1,0,0]
    v_pk_fma_f32 v[62:63], v[62:63], v[244:245], v[244:245] op_sel_hi:[1,0,0]
    v_rcp_f32 v56, v56
    v_rcp_f32 v57, v57
    v_rcp_f32 v58, v58
    v_rcp_f32 v59, v59
    v_rcp_f32 v60, v60
    v_rcp_f32 v61, v61
    v_rcp_f32 v62, v62
    v_rcp_f32 v63, v63
    v_pk_mul_f32 v[108:109], v[108:109], v[56:57]
    v_pk_mul_f32 v[110:111], v[110:111], v[58:59]
    v_pk_mul_f32 v[112:113], v[112:113], v[60:61]
    v_pk_mul_f32 v[114:115], v[114:115], v[62:63]
    v_cvt_pk_bf16_f32 v80, v108, v109
    v_cvt_pk_bf16_f32 v81, v110, v111
    v_cvt_pk_bf16_f32 v82, v112, v113
    v_cvt_pk_bf16_f32 v83, v114, v115
    buffer_store_dwordx4 v[80:83], v2, s[4:7], s72 offen offset:1024 sc1
    s_setprio 1
    v_pk_fma_f32 v[116:117], v[36:37], v[242:243], v[116:117] op_sel_hi:[1,0,1] neg_lo:[1,0,0] neg_hi:[1,0,0]
    v_pk_fma_f32 v[118:119], v[38:39], v[242:243], v[118:119] op_sel_hi:[1,0,1] neg_lo:[1,0,0] neg_hi:[1,0,0]
    v_pk_fma_f32 v[120:121], v[40:41], v[242:243], v[120:121] op_sel_hi:[1,0,1] neg_lo:[1,0,0] neg_hi:[1,0,0]
    v_pk_fma_f32 v[122:123], v[42:43], v[242:243], v[122:123] op_sel_hi:[1,0,1] neg_lo:[1,0,0] neg_hi:[1,0,0]
    v_pk_fma_f32 v[124:125], v[44:45], v[242:243], v[124:125] op_sel_hi:[1,0,1] neg_lo:[1,0,0] neg_hi:[1,0,0]
    v_pk_fma_f32 v[126:127], v[46:47], v[242:243], v[126:127] op_sel_hi:[1,0,1] neg_lo:[1,0,0] neg_hi:[1,0,0]
    v_pk_fma_f32 v[116:117], v[64:65], v[244:245], v[116:117] op_sel_hi:[1,0,1]
    v_pk_fma_f32 v[118:119], v[66:67], v[244:245], v[118:119] op_sel_hi:[1,0,1]
    v_pk_fma_f32 v[120:121], v[68:69], v[244:245], v[120:121] op_sel_hi:[1,0,1]
    v_pk_fma_f32 v[122:123], v[70:71], v[244:245], v[122:123] op_sel_hi:[1,0,1]
    v_pk_fma_f32 v[124:125], v[72:73], v[244:245], v[124:125] op_sel_hi:[1,0,1]
    v_pk_fma_f32 v[126:127], v[74:75], v[244:245], v[126:127] op_sel_hi:[1,0,1]
    v_pk_mul_f32 v[64:65], v[116:117], v[116:117]
    v_pk_mul_f32 v[66:67], v[118:119], v[118:119]
    v_pk_mul_f32 v[68:69], v[120:121], v[120:121]
    v_pk_mul_f32 v[70:71], v[122:123], v[122:123]
    v_pk_mul_f32 v[72:73], v[124:125], v[124:125]
    v_pk_mul_f32 v[74:75], v[126:127], v[126:127]
    v_pk_fma_f32 v[64:65], v[64:65], v[246:247], v[252:253] op_sel_hi:[1,0,0]
    v_pk_fma_f32 v[66:67], v[66:67], v[246:247], v[252:253] op_sel_hi:[1,0,0]
    v_pk_fma_f32 v[68:69], v[68:69], v[246:247], v[252:253] op_sel_hi:[1,0,0]
    v_pk_fma_f32 v[70:71], v[70:71], v[246:247], v[252:253] op_sel_hi:[1,0,0]
    v_pk_fma_f32 v[72:73], v[72:73], v[246:247], v[252:253] op_sel_hi:[1,0,0]
    v_pk_fma_f32 v[74:75], v[74:75], v[246:247], v[252:253] op_sel_hi:[1,0,0]
    v_pk_mul_f32 v[64:65], v[64:65], v[116:117]
    v_pk_mul_f32 v[66:67], v[66:67], v[118:119]
    v_pk_mul_f32 v[68:69], v[68:69], v[120:121]
    v_pk_mul_f32 v[70:71], v[70:71], v[122:123]
    v_pk_mul_f32 v[72:73], v[72:73], v[124:125]
    v_pk_mul_f32 v[74:75], v[74:75], v[126:127]
    v_exp_f32 v64, v64
    v_exp_f32 v65, v65
    v_exp_f32 v66, v66
    v_exp_f32 v67, v67
    v_exp_f32 v68, v68
    v_exp_f32 v69, v69
    v_exp_f32 v70, v70
    v_exp_f32 v71, v71
    v_exp_f32 v72, v72
    v_exp_f32 v73, v73
    v_exp_f32 v74, v74
    v_exp_f32 v75, v75
    v_pk_fma_f32 v[64:65], v[64:65], v[244:245], v[244:245] op_sel_hi:[1,0,0]
    v_pk_fma_f32 v[66:67], v[66:67], v[244:245], v[244:245] op_sel_hi:[1,0,0]
    v_pk_fma_f32 v[68:69], v[68:69], v[244:245], v[244:245] op_sel_hi:[1,0,0]
    v_pk_fma_f32 v[70:71], v[70:71], v[244:245], v[244:245] op_sel_hi:[1,0,0]
    v_pk_fma_f32 v[72:73], v[72:73], v[244:245], v[244:245] op_sel_hi:[1,0,0]
    v_pk_fma_f32 v[74:75], v[74:75], v[244:245], v[244:245] op_sel_hi:[1,0,0]
    v_rcp_f32 v64, v64
    v_rcp_f32 v65, v65
    v_rcp_f32 v66, v66
    v_rcp_f32 v67, v67
    v_rcp_f32 v68, v68
    v_rcp_f32 v69, v69
    v_rcp_f32 v70, v70
    v_rcp_f32 v71, v71
    v_rcp_f32 v72, v72
    v_rcp_f32 v73, v73
    v_rcp_f32 v74, v74
    v_rcp_f32 v75, v75
    v_pk_mul_f32 v[116:117], v[116:117], v[64:65]
    v_pk_mul_f32 v[118:119], v[118:119], v[66:67]
    v_pk_mul_f32 v[120:121], v[120:121], v[68:69]
    v_pk_mul_f32 v[122:123], v[122:123], v[70:71]
    v_pk_mul_f32 v[124:125], v[124:125], v[72:73]
    v_pk_mul_f32 v[126:127], v[126:127], v[74:75]
    v_cvt_pk_bf16_f32 v84, v116, v117
    v_cvt_pk_bf16_f32 v85, v118, v119
    v_cvt_pk_bf16_f32 v86, v120, v121
    v_cvt_pk_bf16_f32 v87, v122, v123
    buffer_store_dwordx4 v[84:87], v2, s[4:7], s72 offen offset:2048 sc1
    v_cvt_pk_bf16_f32 v88, v124, v125
    v_cvt_pk_bf16_f32 v89, v126, v127
    v_mov_b32 v94, v88
    v_mov_b32 v95, v89
    v_mov_b32 v90, v88
    v_mov_b32 v91, v89
    v_lshrrev_b32 v7, 1, v4
    v_lshlrev_b32 v7, 8, v7
    v_lshl_add_u32 v7, v3, 4, v7
    v_permlane16_swap_b32 v94, v92
    v_permlane16_swap_b32 v95, v93
    s_mov_b32 exec_lo, 0xffff
    s_mov_b32 exec_hi, 0xffff
    buffer_store_dwordx4 v[90:93], v7, s[4:7], s73 offen sc1
    s_mov_b64 exec, -1
    s_setprio 0
    ds_read_b128 v[96:99], v254 offset:51200
    ds_read_b128 v[100:103], v254 offset:52224
    ds_read_b128 v[104:107], v254 offset:53248
    ds_read_b128 v[108:111], v254 offset:54272
    ds_read_b128 v[112:115], v254 offset:55296
    ds_read_b128 v[116:119], v255 offset:0
    ds_read_b128 v[120:123], v255 offset:1024
    ds_read_b128 v[124:127], v255 offset:2048
    ds_read_b128 v[20:23], v255 offset:3072
    ds_read_b128 v[24:27], v255 offset:4096
    ds_read_b128 v[28:31], v255 offset:10240
    ds_read_b128 v[32:35], v255 offset:11264
    ds_read_b128 v[36:39], v255 offset:12288
    ds_read_b128 v[40:43], v255 offset:13312
    ds_read_b128 v[44:47], v255 offset:14336
    s_lshl_b32 s50, s80, 7
    s_add_u32 s50, s50, 22551552
    s_lshl_b32 s51, s27, 2
    s_add_u32 s51, s51, s50
    s_waitcnt vmcnt(0)
    s_waitcnt lgkmcnt(0)
    s_barrier
    s_cmp_lg_u32 s20, 0
    s_cbranch_scc1 L_sequ_w0_67
    v_mov_b32 v11, 0
    v_mov_b32 v12, s3
    s_mov_b64 exec, 1
    s_cmp_eq_u32 s35, 1
    s_cbranch_scc0 L_sequ_hs_68
    buffer_store_dword v12, v11, s[4:7], s51 offen
L_sequ_hb_69:
    s_mov_b64 exec, -1
L_sequ_w0_67:
    s_mul_i32 s53, s22, 160
    s_lshl_b32 s54, s24, 6
    s_add_u32 s54, s54, s53
    v_lshlrev_b32 v8, 3, v4
    s_mov_b32 s60, s53
    s_mov_b32 s61, s54
    s_cmp_eq_u32 s20, 0
    s_cbranch_scc1 L_mega_sk1
    s_add_u32 m0, s66, 24576
    s_add_u32 s65, s67, 188416
    buffer_load_dwordx4 v2, s[4:7], s65 offen sc1 lds
    s_add_u32 m0, s66, 32768
    s_add_u32 s65, s67, 196608
    buffer_load_dwordx4 v2, s[4:7], s65 offen sc1 lds
    s_add_u32 m0, s66, 40960
    s_add_u32 s65, s67, 204800
    buffer_load_dwordx4 v2, s[4:7], s65 offen sc1 lds
    s_add_u32 m0, s66, 49152
    s_add_u32 s65, s67, 212992
    buffer_load_dwordx4 v2, s[4:7], s65 offen sc1 lds
    s_add_u32 m0, s66, 57344
    s_add_u32 s65, s67, 221184
    buffer_load_dwordx4 v2, s[4:7], s65 offen sc1 lds
    s_min_u32 s64, s20, 5
    s_lshl_b32 s64, s64, 13
    s_add_u32 m0, s64, 16384
    s_sub_u32 s65, s67, s66
    s_add_u32 s65, s65, m0
    s_add_u32 s65, s65, 163840
    buffer_load_dwordx4 v2, s[4:7], s65 offen sc1 lds
L_mega_sk1:
    s_mul_i32 s52, s79, 55296
    s_mul_i32 s59, s24, 27648
    s_add_u32 s52, s52, s59
    s_add_u32 s52, s52, 8388608
    s_add_u32 s53, s52, 4096
    s_add_u32 s54, s52, 8192
    s_add_u32 s55, s52, 12288
    s_add_u32 s56, s52, 16384
    s_add_u32 s57, s52, 20480
    s_add_u32 s58, s52, 24576
    s_cmp_lg_u32 s20, 0
    s_cbranch_scc1 L_sequ_w0_70
    v_lshlrev_b32 v11, 2, v1
    s_mov_b64 exec, 65535
    s_mov_b32 s78, 0
L_sequ_poll_71:
    buffer_load_dword v12, v11, s[4:7], s50 offen sc1
    s_add_u32 s78, s78, 1
    s_waitcnt vmcnt(0)
    v_cmp_ne_u32 vcc, s3, v12
    s_cmp_gt_u32 s78, 0x40000
    s_cbranch_scc1 L_sequ_polld_72
    s_cbranch_vccnz L_sequ_poll_71
L_sequ_polld_72:
    s_mov_b64 exec, -1
L_sequ_w0_70:
    s_waitcnt vmcnt(13)
    s_barrier
    buffer_load_dwordx4 v[48:51], v2, s[4:7], s52 offen offset:0 sc1
    s_waitcnt vmcnt(6)
    buffer_load_dwordx4 v[52:55], v2, s[4:7], s52 offen offset:1024 sc1
    s_waitcnt vmcnt(6)
    buffer_load_dwordx4 v[56:59], v2, s[4:7], s52 offen offset:2048 sc1
    s_waitcnt vmcnt(6)
    buffer_load_dwordx4 v[60:63], v2, s[4:7], s52 offen offset:3072 sc1
    s_waitcnt vmcnt(6)
    buffer_load_dwordx4 v[64:67], v2, s[4:7], s53 offen offset:0 sc1
    s_waitcnt vmcnt(6)
    buffer_load_dwordx4 v[68:71], v2, s[4:7], s53 offen offset:1024 sc1
    s_waitcnt vmcnt(5)
    s_setprio 3
    v_mfma_f32_16x16x32_bf16 v[228:231], v[128:131], v[48:51], 0
    v_mfma_f32_16x16x32_bf16 v[232:235], v[132:135], v[48:51], 0
    v_mfma_f32_16x16x32_bf16 v[236:239], v[136:139], v[48:51], 0
    v_mfma_f32_16x16x32_bf16 v[240:243], v[140:143], v[48:51], 0
    v_mfma_f32_16x16x32_bf16 v[244:247], v[144:147], v[48:51], 0
    buffer_load_dwordx4 v[72:75], v2, s[4:7], s53 offen offset:2048 sc1
    s_add_u32 m0, s66, 65536
    s_add_u32 s65, s67, 229376
    buffer_load_dwordx4 v2, s[4:7], s65 offen sc1 lds
    s_waitcnt vmcnt(6)
    v_mfma_f32_16x16x32_bf16 v[228:231], v[148:151], v[52:55], v[228:231]
    ds_read_b128 v[128:131], v255 offset:20480
    v_mfma_f32_16x16x32_bf16 v[232:235], v[152:155], v[52:55], v[232:235]
    ds_read_b128 v[132:135], v255 offset:21504
    v_mfma_f32_16x16x32_bf16 v[236:239], v[156:159], v[52:55], v[236:239]
    ds_read_b128 v[136:139], v255 offset:22528
    v_mfma_f32_16x16x32_bf16 v[240:243], v[160:163], v[52:55], v[240:243]
    ds_read_b128 v[140:143], v255 offset:23552
    v_mfma_f32_16x16x32_bf16 v[244:247], v[164:167], v[52:55], v[244:247]
    ds_read_b128 v[144:147], v255 offset:24576
    buffer_load_dwordx4 v[76:79], v2, s[4:7], s53 offen offset:3072 sc1
    s_add_u32 m0, s66, 73728
    s_add_u32 s65, s67, 237568
    s_waitcnt vmcnt(6)
    buffer_load_dwordx4 v2, s[4:7], s65 offen sc1 lds
    s_waitcnt vmcnt(7)
    v_mfma_f32_16x16x32_bf16 v[228:231], v[168:171], v[56:59], v[228:231]
    ds_read_b128 v[148:151], v255 offset:30720
    v_mfma_f32_16x16x32_bf16 v[232:235], v[172:175], v[56:59], v[232:235]
    ds_read_b128 v[152:155], v255 offset:31744
    v_mfma_f32_16x16x32_bf16 v[236:239], v[176:179], v[56:59], v[236:239]
    ds_read_b128 v[156:159], v255 offset:32768
    v_mfma_f32_16x16x32_bf16 v[240:243], v[180:183], v[56:59], v[240:243]
    ds_read_b128 v[160:163], v255 offset:33792
    v_mfma_f32_16x16x32_bf16 v[244:247], v[184:187], v[56:59], v[244:247]
    ds_read_b128 v[164:167], v255 offset:34816
    s_waitcnt vmcnt(6)
    buffer_load_dwordx4 v[80:83], v2, s[4:7], s54 offen offset:0 sc1
    s_waitcnt vmcnt(7)
    s_setprio 2
    v_mfma_f32_16x16x32_bf16 v[228:231], v[188:191], v[60:63], v[228:231]
    ds_read_b128 v[168:171], v255 offset:40960
    v_mfma_f32_16x16x32_bf16 v[232:235], v[192:195], v[60:63], v[232:235]
    ds_read_b128 v[172:175], v255 offset:41984
    v_mfma_f32_16x16x32_bf16 v[236:239], v[196:199], v[60:63], v[236:239]
    ds_read_b128 v[176:179], v255 offset:43008
    v_mfma_f32_16x16x32_bf16 v[240:243], v[200:203], v[60:63], v[240:243]
    ds_read_b128 v[180:183], v255 offset:44032
    v_mfma_f32_16x16x32_bf16 v[244:247], v[204:207], v[60:63], v[244:247]
    ds_read_b128 v[184:187], v255 offset:45056
    s_waitcnt vmcnt(6)
    buffer_load_dwordx4 v[84:87], v2, s[4:7], s54 offen offset:1024 sc1
    s_waitcnt vmcnt(7)
    v_mfma_f32_16x16x32_bf16 v[228:231], v[208:211], v[64:67], v[228:231]
    ds_read_b128 v[188:191], v255 offset:51200
    v_mfma_f32_16x16x32_bf16 v[232:235], v[212:215], v[64:67], v[232:235]
    ds_read_b128 v[192:195], v255 offset:52224
    v_mfma_f32_16x16x32_bf16 v[236:239], v[216:219], v[64:67], v[236:239]
    ds_read_b128 v[196:199], v255 offset:53248
    v_mfma_f32_16x16x32_bf16 v[240:243], v[220:223], v[64:67], v[240:243]
    ds_read_b128 v[200:203], v255 offset:54272
    v_mfma_f32_16x16x32_bf16 v[244:247], v[224:227], v[64:67], v[244:247]
    ds_read_b128 v[204:207], v255 offset:55296
    s_waitcnt vmcnt(6)
    buffer_load_dwordx4 v[88:91], v2, s[4:7], s54 offen offset:2048 sc1
    s_waitcnt vmcnt(7)
    s_setprio 1
    v_mfma_f32_16x16x32_bf16 v[228:231], v[96:99], v[68:71], v[228:231]
    ds_read_b128 v[208:211], v13 offset:0
    v_mfma_f32_16x16x32_bf16 v[232:235], v[100:103], v[68:71], v[232:235]
    ds_read_b128 v[212:215], v13 offset:1024
    v_mfma_f32_16x16x32_bf16 v[236:239], v[104:107], v[68:71], v[236:239]
    ds_read_b128 v[216:219], v13 offset:2048
    v_mfma_f32_16x16x32_bf16 v[240:243], v[108:111], v[68:71], v[240:243]
    ds_read_b128 v[220:223], v13 offset:3072
    v_mfma_f32_16x16x32_bf16 v[244:247], v[112:115], v[68:71], v[244:247]
    ds_read_b128 v[224:227], v13 offset:4096
    s_waitcnt vmcnt(6)
    buffer_load_dwordx4 v[92:95], v2, s[4:7], s54 offen offset:3072 sc1
    s_waitcnt vmcnt(7)
    v_mfma_f32_16x16x32_bf16 v[228:231], v[116:119], v[72:75], v[228:231]
    ds_read_b128 v[96:99], v13 offset:10240
    v_mfma_f32_16x16x32_bf16 v[232:235], v[120:123], v[72:75], v[232:235]
    ds_read_b128 v[100:103], v13 offset:11264
    v_mfma_f32_16x16x32_bf16 v[236:239], v[124:127], v[72:75], v[236:239]
    ds_read_b128 v[104:107], v13 offset:12288
    v_mfma_f32_16x16x32_bf16 v[240:243], v[20:23], v[72:75], v[240:243]
    ds_read_b128 v[108:111], v13 offset:13312
    v_mfma_f32_16x16x32_bf16 v[244:247], v[24:27], v[72:75], v[244:247]
    ds_read_b128 v[112:115], v13 offset:14336
    s_waitcnt vmcnt(6)
    buffer_load_dwordx4 v[48:51], v2, s[4:7], s55 offen offset:0 sc1
    s_waitcnt vmcnt(6)
    s_setprio 0
    v_mfma_f32_16x16x32_bf16 v[228:231], v[28:31], v[76:79], v[228:231]
    ds_read_b128 v[116:119], v13 offset:20480
    v_mfma_f32_16x16x32_bf16 v[232:235], v[32:35], v[76:79], v[232:235]
    ds_read_b128 v[120:123], v13 offset:21504
    v_mfma_f32_16x16x32_bf16 v[236:239], v[36:39], v[76:79], v[236:239]
    ds_read_b128 v[124:127], v13 offset:22528
    v_mfma_f32_16x16x32_bf16 v[240:243], v[40:43], v[76:79], v[240:243]
    ds_read_b128 v[20:23], v13 offset:23552
    v_mfma_f32_16x16x32_bf16 v[244:247], v[44:47], v[76:79], v[244:247]
    ds_read_b128 v[24:27], v13 offset:24576
    buffer_load_dwordx4 v[52:55], v2, s[4:7], s55 offen offset:1024 sc1
    s_waitcnt vmcnt(5)
    s_waitcnt lgkmcnt(15)
    v_mfma_f32_16x16x32_bf16 v[228:231], v[128:131], v[80:83], v[228:231]
    ds_read_b128 v[28:31], v13 offset:30720
    v_mfma_f32_16x16x32_bf16 v[232:235], v[132:135], v[80:83], v[232:235]
    ds_read_b128 v[32:35], v13 offset:31744
    v_mfma_f32_16x16x32_bf16 v[236:239], v[136:139], v[80:83], v[236:239]
    ds_read_b128 v[36:39], v13 offset:32768
    v_mfma_f32_16x16x32_bf16 v[240:243], v[140:143], v[80:83], v[240:243]
    ds_read_b128 v[40:43], v13 offset:33792
    v_mfma_f32_16x16x32_bf16 v[244:247], v[144:147], v[80:83], v[244:247]
    ds_read_b128 v[44:47], v13 offset:34816
    buffer_load_dwordx4 v[56:59], v2, s[4:7], s55 offen offset:2048 sc1
    s_waitcnt vmcnt(5)
    s_waitcnt vmcnt(7)
    s_waitcnt lgkmcnt(0)
    s_barrier
    s_setprio 3
    v_mfma_f32_16x16x32_bf16 v[228:231], v[148:151], v[84:87], v[228:231]
    ds_read_b128 v[128:131], v254 offset:0
    v_mfma_f32_16x16x32_bf16 v[232:235], v[152:155], v[84:87], v[232:235]
    ds_read_b128 v[132:135], v254 offset:1024
    v_mfma_f32_16x16x32_bf16 v[236:239], v[156:159], v[84:87], v[236:239]
    ds_read_b128 v[136:139], v254 offset:2048
    v_mfma_f32_16x16x32_bf16 v[240:243], v[160:163], v[84:87], v[240:243]
    ds_read_b128 v[140:143], v254 offset:3072
    v_mfma_f32_16x16x32_bf16 v[244:247], v[164:167], v[84:87], v[244:247]
    ds_read_b128 v[144:147], v254 offset:4096
    buffer_load_dwordx4 v[60:63], v2, s[4:7], s55 offen offset:3072 sc1
    s_add_u32 m0, s66, 81920
    s_add_u32 s65, s67, 245760
    buffer_load_dwordx4 v2, s[4:7], s65 offen sc1 lds
    s_waitcnt vmcnt(6)
    s_waitcnt lgkmcnt(15)
    v_mfma_f32_16x16x32_bf16 v[228:231], v[168:171], v[88:91], v[228:231]
    ds_read_b128 v[148:151], v254 offset:10240
    v_mfma_f32_16x16x32_bf16 v[232:235], v[172:175], v[88:91], v[232:235]
    ds_read_b128 v[152:155], v254 offset:11264
    v_mfma_f32_16x16x32_bf16 v[236:239], v[176:179], v[88:91], v[236:239]
    ds_read_b128 v[156:159], v254 offset:12288
    v_mfma_f32_16x16x32_bf16 v[240:243], v[180:183], v[88:91], v[240:243]
    ds_read_b128 v[160:163], v254 offset:13312
    v_mfma_f32_16x16x32_bf16 v[244:247], v[184:187], v[88:91], v[244:247]
    ds_read_b128 v[164:167], v254 offset:14336
    buffer_load_dwordx4 v[64:67], v2, s[4:7], s56 offen offset:0 sc1
    s_add_u32 m0, s66, 90112
    s_add_u32 s65, s67, 253952
    s_waitcnt vmcnt(6)
    buffer_load_dwordx4 v2, s[4:7], s65 offen sc1 lds
    s_waitcnt vmcnt(7)
    s_waitcnt lgkmcnt(15)
    s_setprio 2
    v_mfma_f32_16x16x32_bf16 v[228:231], v[188:191], v[92:95], v[228:231]
    ds_read_b128 v[168:171], v254 offset:20480
    v_mfma_f32_16x16x32_bf16 v[232:235], v[192:195], v[92:95], v[232:235]
    ds_read_b128 v[172:175], v254 offset:21504
    v_mfma_f32_16x16x32_bf16 v[236:239], v[196:199], v[92:95], v[236:239]
    ds_read_b128 v[176:179], v254 offset:22528
    v_mfma_f32_16x16x32_bf16 v[240:243], v[200:203], v[92:95], v[240:243]
    ds_read_b128 v[180:183], v254 offset:23552
    v_mfma_f32_16x16x32_bf16 v[244:247], v[204:207], v[92:95], v[244:247]
    ds_read_b128 v[184:187], v254 offset:24576
    s_waitcnt vmcnt(6)
    buffer_load_dwordx4 v[68:71], v2, s[4:7], s56 offen offset:1024 sc1
    s_add_u32 m0, s66, 98304
    s_add_u32 s65, s67, 262144
    s_waitcnt vmcnt(6)
    buffer_load_dwordx4 v2, s[4:7], s65 offen sc1 lds
    s_waitcnt vmcnt(8)
    s_waitcnt lgkmcnt(15)
    v_mfma_f32_16x16x32_bf16 v[228:231], v[208:211], v[48:51], v[228:231]
    ds_read_b128 v[188:191], v254 offset:30720
    v_mfma_f32_16x16x32_bf16 v[232:235], v[212:215], v[48:51], v[232:235]
    ds_read_b128 v[192:195], v254 offset:31744
    v_mfma_f32_16x16x32_bf16 v[236:239], v[216:219], v[48:51], v[236:239]
    ds_read_b128 v[196:199], v254 offset:32768
    v_mfma_f32_16x16x32_bf16 v[240:243], v[220:223], v[48:51], v[240:243]
    ds_read_b128 v[200:203], v254 offset:33792
    v_mfma_f32_16x16x32_bf16 v[244:247], v[224:227], v[48:51], v[244:247]
    ds_read_b128 v[204:207], v254 offset:34816
    s_waitcnt vmcnt(6)
    buffer_load_dwordx4 v[72:75], v2, s[4:7], s56 offen offset:2048 sc1
    s_min_u32 s64, s66, 5120
    s_sub_u32 s67, s67, s66
    s_add_u32 s67, s67, s64
    s_mov_b32 s66, s64
    s_add_u32 m0, s66, 106496
    s_add_u32 s65, s67, 270336
    s_waitcnt vmcnt(6)
    buffer_load_dwordx4 v2, s[4:7], s65 offen sc1 lds
    s_waitcnt vmcnt(9)
    s_waitcnt lgkmcnt(15)
    s_setprio 1
    v_mfma_f32_16x16x32_bf16 v[228:231], v[96:99], v[52:55], v[228:231]
    ds_read_b128 v[208:211], v254 offset:40960
    v_mfma_f32_16x16x32_bf16 v[232:235], v[100:103], v[52:55], v[232:235]
    ds_read_b128 v[212:215], v254 offset:41984
    v_mfma_f32_16x16x32_bf16 v[236:239], v[104:107], v[52:55], v[236:239]
    ds_read_b128 v[216:219], v254 offset:43008
    v_mfma_f32_16x16x32_bf16 v[240:243], v[108:111], v[52:55], v[240:243]
    ds_read_b128 v[220:223], v254 offset:44032
    v_mfma_f32_16x16x32_bf16 v[244:247], v[112:115], v[52:55], v[244:247]
    ds_read_b128 v[224:227], v254 offset:45056
    s_waitcnt vmcnt(6)
    buffer_load_dwordx4 v[76:79], v2, s[4:7], s56 offen offset:3072 sc1
    s_waitcnt vmcnt(9)
    s_waitcnt lgkmcnt(15)
    v_mfma_f32_16x16x32_bf16 v[228:231], v[116:119], v[56:59], v[228:231]
    ds_read_b128 v[96:99], v254 offset:51200
    v_mfma_f32_16x16x32_bf16 v[232:235], v[120:123], v[56:59], v[232:235]
    ds_read_b128 v[100:103], v254 offset:52224
    v_mfma_f32_16x16x32_bf16 v[236:239], v[124:127], v[56:59], v[236:239]
    ds_read_b128 v[104:107], v254 offset:53248
    v_mfma_f32_16x16x32_bf16 v[240:243], v[20:23], v[56:59], v[240:243]
    ds_read_b128 v[108:111], v254 offset:54272
    v_mfma_f32_16x16x32_bf16 v[244:247], v[24:27], v[56:59], v[244:247]
    ds_read_b128 v[112:115], v254 offset:55296
    s_waitcnt vmcnt(6)
    buffer_load_dwordx4 v[80:83], v2, s[4:7], s57 offen offset:0 sc1
    s_waitcnt vmcnt(6)
    buffer_load_dwordx2 v[248:249], v8, s[16:19], s61 offen
    s_waitcnt vmcnt(6)
    buffer_load_dwordx2 v[250:251], v8, s[16:19], s61 offen offset:32
    s_waitcnt vmcnt(6)
    buffer_load_dwordx2 v[252:253], v8, s[16:19], s60 offen offset:128
    s_waitcnt vmcnt(12)
    s_waitcnt lgkmcnt(15)
    s_setprio 0
    v_mfma_f32_16x16x32_bf16 v[228:231], v[28:31], v[60:63], v[228:231]
    ds_read_b128 v[116:119], v255 offset:0
    v_mfma_f32_16x16x32_bf16 v[232:235], v[32:35], v[60:63], v[232:235]
    ds_read_b128 v[120:123], v255 offset:1024
    v_mfma_f32_16x16x32_bf16 v[236:239], v[36:39], v[60:63], v[236:239]
    ds_read_b128 v[124:127], v255 offset:2048
    v_mfma_f32_16x16x32_bf16 v[240:243], v[40:43], v[60:63], v[240:243]
    ds_read_b128 v[20:23], v255 offset:3072
    v_mfma_f32_16x16x32_bf16 v[244:247], v[44:47], v[60:63], v[244:247]
    ds_read_b128 v[24:27], v255 offset:4096
    s_waitcnt vmcnt(6)
    buffer_load_dwordx4 v[84:87], v2, s[4:7], s57 offen offset:1024 sc1
    s_waitcnt vmcnt(11)
    s_waitcnt lgkmcnt(15)
    v_mfma_f32_16x16x32_bf16 v[228:231], v[128:131], v[64:67], v[228:231]
    ds_read_b128 v[28:31], v255 offset:10240
    v_mfma_f32_16x16x32_bf16 v[232:235], v[132:135], v[64:67], v[232:235]
    ds_read_b128 v[32:35], v255 offset:11264
    v_mfma_f32_16x16x32_bf16 v[236:239], v[136:139], v[64:67], v[236:239]
    ds_read_b128 v[36:39], v255 offset:12288
    v_mfma_f32_16x16x32_bf16 v[240:243], v[140:143], v[64:67], v[240:243]
    ds_read_b128 v[40:43], v255 offset:13312
    v_mfma_f32_16x16x32_bf16 v[244:247], v[144:147], v[64:67], v[244:247]
    ds_read_b128 v[44:47], v255 offset:14336
    s_waitcnt vmcnt(6)
    buffer_load_dwordx4 v[88:91], v2, s[4:7], s57 offen offset:2048 sc1
    s_waitcnt vmcnt(10)
    s_waitcnt vmcnt(7)
    s_waitcnt lgkmcnt(15)
    s_barrier
    s_setprio 3
    v_mfma_f32_16x16x32_bf16 v[228:231], v[148:151], v[68:71], v[228:231]
    ds_read_b128 v[128:131], v255 offset:20480
    v_mfma_f32_16x16x32_bf16 v[232:235], v[152:155], v[68:71], v[232:235]
    ds_read_b128 v[132:135], v255 offset:21504
    v_mfma_f32_16x16x32_bf16 v[236:239], v[156:159], v[68:71], v[236:239]
    ds_read_b128 v[136:139], v255 offset:22528
    v_mfma_f32_16x16x32_bf16 v[240:243], v[160:163], v[68:71], v[240:243]
    ds_read_b128 v[140:143], v255 offset:23552
    v_mfma_f32_16x16x32_bf16 v[244:247], v[164:167], v[68:71], v[244:247]
    ds_read_b128 v[144:147], v255 offset:24576
    s_waitcnt vmcnt(6)
    buffer_load_dwordx4 v[92:95], v2, s[4:7], s57 offen offset:3072 sc1
    s_waitcnt vmcnt(9)
    s_waitcnt lgkmcnt(15)
    v_mfma_f32_16x16x32_bf16 v[228:231], v[168:171], v[72:75], v[228:231]
    ds_read_b128 v[148:151], v255 offset:30720
    v_mfma_f32_16x16x32_bf16 v[232:235], v[172:175], v[72:75], v[232:235]
    ds_read_b128 v[152:155], v255 offset:31744
    v_mfma_f32_16x16x32_bf16 v[236:239], v[176:179], v[72:75], v[236:239]
    ds_read_b128 v[156:159], v255 offset:32768
    v_mfma_f32_16x16x32_bf16 v[240:243], v[180:183], v[72:75], v[240:243]
    ds_read_b128 v[160:163], v255 offset:33792
    v_mfma_f32_16x16x32_bf16 v[244:247], v[184:187], v[72:75], v[244:247]
    ds_read_b128 v[164:167], v255 offset:34816
    s_waitcnt vmcnt(6)
    buffer_load_dwordx4 v[48:51], v2, s[4:7], s58 offen offset:0 sc1
    s_waitcnt vmcnt(8)
    s_waitcnt lgkmcnt(15)
    v_mfma_f32_16x16x32_bf16 v[228:231], v[188:191], v[76:79], v[228:231]
    ds_read_b128 v[168:171], v255 offset:40960
    v_mfma_f32_16x16x32_bf16 v[232:235], v[192:195], v[76:79], v[232:235]
    ds_read_b128 v[172:175], v255 offset:41984
    v_mfma_f32_16x16x32_bf16 v[236:239], v[196:199], v[76:79], v[236:239]
    ds_read_b128 v[176:179], v255 offset:43008
    v_mfma_f32_16x16x32_bf16 v[240:243], v[200:203], v[76:79], v[240:243]
    ds_read_b128 v[180:183], v255 offset:44032
    v_mfma_f32_16x16x32_bf16 v[244:247], v[204:207], v[76:79], v[244:247]
    ds_read_b128 v[184:187], v255 offset:45056
    s_waitcnt vmcnt(6)
    buffer_load_dwordx4 v[52:55], v2, s[4:7], s58 offen offset:1024 sc1
    s_waitcnt vmcnt(8)
    s_waitcnt lgkmcnt(15)
    s_setprio 2
    v_mfma_f32_16x16x32_bf16 v[228:231], v[208:211], v[80:83], v[228:231]
    v_mfma_f32_16x16x32_bf16 v[232:235], v[212:215], v[80:83], v[232:235]
    v_mfma_f32_16x16x32_bf16 v[236:239], v[216:219], v[80:83], v[236:239]
    v_mfma_f32_16x16x32_bf16 v[240:243], v[220:223], v[80:83], v[240:243]
    v_mfma_f32_16x16x32_bf16 v[244:247], v[224:227], v[80:83], v[244:247]
    s_waitcnt vmcnt(6)
    buffer_load_dwordx4 v[56:59], v2, s[4:7], s58 offen offset:2048 sc1
    s_waitcnt vmcnt(5)
    s_waitcnt lgkmcnt(15)
    v_mfma_f32_16x16x32_bf16 v[228:231], v[96:99], v[84:87], v[228:231]
    s_waitcnt vmcnt(6)
    v_lshlrev_b32 v200, 16, v14
    v_mfma_f32_16x16x32_bf16 v[232:235], v[100:103], v[84:87], v[232:235]
    v_and_b32 v201, 0xffff0000, v14
    v_lshlrev_b32 v202, 16, v15
    v_mfma_f32_16x16x32_bf16 v[236:239], v[104:107], v[84:87], v[236:239]
    v_and_b32 v203, 0xffff0000, v15
    v_lshlrev_b32 v212, 16, v248
    v_mfma_f32_16x16x32_bf16 v[240:243], v[108:111], v[84:87], v[240:243]
    v_and_b32 v213, 0xffff0000, v248
    v_lshlrev_b32 v214, 16, v249
    v_mfma_f32_16x16x32_bf16 v[244:247], v[112:115], v[84:87], v[244:247]
    v_and_b32 v215, 0xffff0000, v249
    v_add_f32 v200, v200, v212
    s_waitcnt vmcnt(4)
    s_waitcnt lgkmcnt(15)
    s_setprio 1
    v_mfma_f32_16x16x32_bf16 v[228:231], v[116:119], v[88:91], v[228:231]
    v_add_f32 v201, v201, v213
    v_add_f32 v202, v202, v214
    v_mfma_f32_16x16x32_bf16 v[232:235], v[120:123], v[88:91], v[232:235]
    v_add_f32 v203, v203, v215
    v_lshlrev_b32 v204, 16, v16
    v_mfma_f32_16x16x32_bf16 v[236:239], v[124:127], v[88:91], v[236:239]
    v_and_b32 v205, 0xffff0000, v16
    v_lshlrev_b32 v206, 16, v17
    v_mfma_f32_16x16x32_bf16 v[240:243], v[20:23], v[88:91], v[240:243]
    v_and_b32 v207, 0xffff0000, v17
    v_lshlrev_b32 v216, 16, v250
    v_mfma_f32_16x16x32_bf16 v[244:247], v[24:27], v[88:91], v[244:247]
    v_and_b32 v217, 0xffff0000, v250
    v_lshlrev_b32 v218, 16, v251
    s_waitcnt vmcnt(3)
    s_waitcnt lgkmcnt(15)
    v_mfma_f32_16x16x32_bf16 v[228:231], v[28:31], v[92:95], v[228:231]
    v_and_b32 v219, 0xffff0000, v251
    v_add_f32 v204, v204, v216
    v_mfma_f32_16x16x32_bf16 v[232:235], v[32:35], v[92:95], v[232:235]
    v_add_f32 v205, v205, v217
    v_add_f32 v206, v206, v218
    v_mfma_f32_16x16x32_bf16 v[236:239], v[36:39], v[92:95], v[236:239]
    v_add_f32 v207, v207, v219
    v_lshlrev_b32 v208, 16, v18
    v_mfma_f32_16x16x32_bf16 v[240:243], v[40:43], v[92:95], v[240:243]
    v_and_b32 v209, 0xffff0000, v18
    v_lshlrev_b32 v210, 16, v19
    v_mfma_f32_16x16x32_bf16 v[244:247], v[44:47], v[92:95], v[244:247]
    v_and_b32 v211, 0xffff0000, v19
    v_lshlrev_b32 v220, 16, v252
    s_waitcnt vmcnt(2)
    s_waitcnt lgkmcnt(10)
    v_mfma_f32_16x16x32_bf16 v[228:231], v[128:131], v[48:51], v[228:231]
    v_and_b32 v221, 0xffff0000, v252
    v_lshlrev_b32 v222, 16, v253
    v_mfma_f32_16x16x32_bf16 v[232:235], v[132:135], v[48:51], v[232:235]
    v_and_b32 v223, 0xffff0000, v253
    v_add_f32 v208, v208, v220
    v_mfma_f32_16x16x32_bf16 v[236:239], v[136:139], v[48:51], v[236:239]
    v_add_f32 v209, v209, v221
    v_add_f32 v210, v210, v222
    v_mfma_f32_16x16x32_bf16 v[240:243], v[140:143], v[48:51], v[240:243]
    v_add_f32 v211, v211, v223
    s_mov_b32 s12, s44
    v_mfma_f32_16x16x32_bf16 v[244:247], v[144:147], v[48:51], v[244:247]
    s_mov_b32 s13, s45
    s_mov_b32 s14, 2621440
    s_waitcnt vmcnt(1)
    s_waitcnt lgkmcnt(5)
    s_setprio 0
    v_mfma_f32_16x16x32_bf16 v[228:231], v[148:151], v[52:55], v[228:231]
    s_mov_b32 s15, 0x00020000
    s_mul_i32 s62, s23, 5120
    v_mfma_f32_16x16x32_bf16 v[232:235], v[152:155], v[52:55], v[232:235]
    s_add_u32 s62, s62, 143360
    s_lshl_b32 s63, s24, 11
    v_mfma_f32_16x16x32_bf16 v[236:239], v[156:159], v[52:55], v[236:239]
    s_add_u32 s62, s62, s63
    v_add_u32 v5, s62, v2
    v_mfma_f32_16x16x32_bf16 v[240:243], v[160:163], v[52:55], v[240:243]
    s_sub_u32 s62, s62, s63
    s_sub_u32 s62, s62, s63
    v_mfma_f32_16x16x32_bf16 v[244:247], v[164:167], v[52:55], v[244:247]
    s_add_u32 s62, s62, 2048
    v_add_u32 v6, s62, v2
    s_waitcnt vmcnt(0)
    s_waitcnt lgkmcnt(0)
    v_mfma_f32_16x16x32_bf16 v[228:231], v[168:171], v[56:59], v[228:231]
    s_mul_i32 s74, s79, 20480
    s_mul_i32 s75, s22, 160
    v_mfma_f32_16x16x32_bf16 v[232:235], v[172:175], v[56:59], v[232:235]
    s_add_u32 s74, s74, s75
    s_lshl_b32 s75, s24, 6
    v_mfma_f32_16x16x32_bf16 v[236:239], v[176:179], v[56:59], v[236:239]
    s_add_u32 s75, s75, s74
    v_mul_u32_u24 v7, 1280, v3
    v_mfma_f32_16x16x32_bf16 v[240:243], v[180:183], v[56:59], v[240:243]
    v_lshl_add_u32 v8, v4, 3, v7
    v_and_b32 v9, 1, v4
    v_mfma_f32_16x16x32_bf16 v[244:247], v[184:187], v[56:59], v[244:247]
    v_lshl_add_u32 v7, v9, 5, v7
    v_lshrrev_b32 v9, 1, v4
    v_lshl_add_u32 v7, v9, 4, v7
    ds_write_b128 v5, v[236:239] offset:0
    s_nop 0
    ds_write_b128 v5, v[240:243] offset:1024
    s_cmp_eq_u32 s24, 0
    s_cbranch_scc1 L_sequ_px_73
    ds_write_b128 v5, v[244:247] offset:2048
L_sequ_px_73:
    s_waitcnt lgkmcnt(0)
    s_barrier
    ds_read_b128 v[188:191], v6 offset:0
    ds_read_b128 v[192:195], v6 offset:1024
    ds_read_b128 v[196:199], v6 offset:2048
    v_pk_add_f32 v[228:229], v[228:229], v[200:201]
    v_pk_add_f32 v[230:231], v[230:231], v[202:203]
    s_waitcnt lgkmcnt(2)
    v_pk_add_f32 v[228:229], v[228:229], v[188:189]
    v_pk_add_f32 v[230:231], v[230:231], v[190:191]
    v_cvt_pk_bf16_f32 v14, v228, v229
    v_cvt_pk_bf16_f32 v15, v230, v231
    v_pk_add_f32 v[232:233], v[232:233], v[204:205]
    v_pk_add_f32 v[234:235], v[234:235], v[206:207]
    s_waitcnt lgkmcnt(1)
    v_pk_add_f32 v[232:233], v[232:233], v[192:193]
    v_pk_add_f32 v[234:235], v[234:235], v[194:195]
    v_cvt_pk_bf16_f32 v16, v232, v233
    v_cvt_pk_bf16_f32 v17, v234, v235
    s_nop 0
    v_permlane16_swap_b32 v14, v16
    v_permlane16_swap_b32 v15, v17
    buffer_store_dwordx4 v[14:17], v7, s[12:15], s75 offen
    s_cmp_eq_u32 s24, 1
    s_cbranch_scc1 L_sequ_t4d_74
    v_pk_add_f32 v[244:245], v[244:245], v[208:209]
    v_pk_add_f32 v[246:247], v[246:247], v[210:211]
    s_waitcnt lgkmcnt(0)
    v_pk_add_f32 v[244:245], v[244:245], v[196:197]
    v_pk_add_f32 v[246:247], v[246:247], v[198:199]
    v_cvt_pk_bf16_f32 v18, v244, v245
    v_cvt_pk_bf16_f32 v19, v246, v247
    buffer_store_dwordx2 v[18:19], v8, s[12:15], s74 offen offset:128
L_sequ_t4d_74:
    s_endpgm
L_mega_end:
    s_endpgm
L_sequ_hs_43:
    buffer_store_dwordx4 v[42:45], v24, s[4:7], 0 offen sc1
    s_nop 1
    s_branch L_sequ_hb_44
L_sequ_hs_45:
    buffer_store_dwordx2 v[46:47], v25, s[4:7], 0 offen sc1
    s_nop 1
    s_branch L_sequ_hb_46
L_sequ_hs_47:
    buffer_store_dwordx4 v[42:45], v24, s[4:7], 0 offen sc1
    s_nop 1
    s_branch L_sequ_hb_48
L_sequ_hs_49:
    buffer_store_dwordx2 v[46:47], v25, s[4:7], 0 offen sc1
    s_nop 1
    s_branch L_sequ_hb_50
L_sequ_hs_52:
    buffer_store_dword v12, v11, s[4:7], s51 offen sc1
    s_nop 1
    s_branch L_sequ_hb_53
L_sequ_hs_61:
    buffer_store_dword v12, v11, s[4:7], s51 offen sc1
    s_nop 1
    s_branch L_sequ_hb_62
L_sequ_hs_68:
    buffer_store_dword v12, v11, s[4:7], s51 offen sc1
    s_nop 1
    s_branch L_sequ_hb_69
L_mega_slow:
    s_waitcnt lgkmcnt(0)
    s_nop 15
    s_nop 3
    v_and_b32 v12, 31, v1
    v_lshlrev_b32 v12, 4, v12
    v_mov_b32 v22, 0xff800000
    v_mov_b32 v23, 0xff800000
    s_mov_b32 s50, 0
L_mega_slow1:
    s_lshl_b32 s51, s50, 10
    s_add_u32 s51, s51, 2621440
    buffer_load_dwordx4 v[184:187], v20, s[4:7], s51 offen sc1
    s_lshl_b32 s54, s24, 5
    s_add_u32 s54, s54, s50
    s_lshr_b32 s53, s54, 2
    s_lshl_b32 s53, s53, 10
    s_and_b32 s55, s54, 1
    s_lshl_b32 s55, s55, 9
    s_add_u32 s53, s53, s55
    s_and_b32 s55, s54, 2
    s_lshl_b32 s55, s55, 2
    s_add_u32 s53, s53, s55
    s_add_u32 s53, s53, 2785280
    buffer_load_dwordx2 v[196:197], v12, s[4:7], s53 offen sc1
    s_mul_i32 s52, s50, 1344
    s_add_u32 s52, s52, 2621440
    buffer_load_dwordx4 v[188:191], v21, s[4:7], s52 offen sc1
    buffer_load_dwordx4 v[192:195], v21, s[4:7], s52 offen offset:672 sc1
    s_waitcnt vmcnt(0)
    v_mfma_f32_32x32x4_2b_bf16 v[30:61], v[196:197], v[166:167], 0 cbsz:1 abid:0
    s_nop 15
    s_nop 1
    v_mfma_f32_32x32x16_bf16 v[30:45], v[184:187], v[158:161], v[30:45]
    v_mfma_f32_32x32x16_bf16 v[46:61], v[184:187], v[162:165], v[46:61]
    s_nop 10
    v_max3_f32 v5, v30, v31, v32
    v_max3_f32 v5, v5, v33, v34
    v_max3_f32 v5, v5, v35, v36
    v_max3_f32 v5, v5, v37, v38
    v_max3_f32 v5, v5, v39, v40
    v_max3_f32 v5, v5, v41, v42
    v_max3_f32 v5, v5, v43, v44
    v_max_f32 v5, v5, v45
    v_max_f32 v22, v22, v5
    v_max3_f32 v6, v46, v47, v48
    v_max3_f32 v6, v6, v49, v50
    v_max3_f32 v6, v6, v51, v52
    v_max3_f32 v6, v6, v53, v54
    v_max3_f32 v6, v6, v55, v56
    v_max3_f32 v6, v6, v57, v58
    v_max3_f32 v6, v6, v59, v60
    v_max_f32 v6, v6, v61
    v_max_f32 v23, v23, v6
    s_add_u32 s50, s50, 1
    s_cmp_lt_u32 s50, 32
    s_cbranch_scc1 L_mega_slow1
    v_mov_b32 v5, v22
    v_mov_b32 v6, v23
    s_nop 0
    v_permlane32_swap_b32 v22, v5
    v_permlane32_swap_b32 v23, v6
    v_max_f32 v22, v22, v5
    v_max_f32 v23, v23, v6
    v_mov_b32 v126, 0
    v_mov_b32 v127, 0
    v_mov_b32 v128, 0
    v_mov_b32 v129, 0
    v_mov_b32 v130, 0
    v_mov_b32 v131, 0
    v_mov_b32 v132, 0
    v_mov_b32 v133, 0
    v_mov_b32 v134, 0
    v_mov_b32 v135, 0
    v_mov_b32 v136, 0
    v_mov_b32 v137, 0
    v_mov_b32 v138, 0
    v_mov_b32 v139, 0
    v_mov_b32 v140, 0
    v_mov_b32 v141, 0
    v_mov_b32 v142, 0
    v_mov_b32 v143, 0
    v_mov_b32 v144, 0
    v_mov_b32 v145, 0
    v_mov_b32 v146, 0
    v_mov_b32 v147, 0
    v_mov_b32 v148, 0
    v_mov_b32 v149, 0
    v_mov_b32 v150, 0
    v_mov_b32 v151, 0
    v_mov_b32 v152, 0
    v_mov_b32 v153, 0
    v_mov_b32 v154, 0
    v_mov_b32 v155, 0
    v_mov_b32 v156, 0
    v_mov_b32 v157, 0
    s_mov_b32 s50, 0
L_mega_slow2:
    s_lshl_b32 s51, s50, 10
    s_add_u32 s51, s51, 2621440
    buffer_load_dwordx4 v[184:187], v20, s[4:7], s51 offen sc1
    s_lshl_b32 s54, s24, 5
    s_add_u32 s54, s54, s50
    s_lshr_b32 s53, s54, 2
    s_lshl_b32 s53, s53, 10
    s_and_b32 s55, s54, 1
    s_lshl_b32 s55, s55, 9
    s_add_u32 s53, s53, s55
    s_and_b32 s55, s54, 2
    s_lshl_b32 s55, s55, 2
    s_add_u32 s53, s53, s55
    s_add_u32 s53, s53, 2785280
    buffer_load_dwordx2 v[196:197], v12, s[4:7], s53 offen sc1
    s_mul_i32 s52, s50, 1344
    s_add_u32 s52, s52, 2621440
    buffer_load_dwordx4 v[188:191], v21, s[4:7], s52 offen sc1
    buffer_load_dwordx4 v[192:195], v21, s[4:7], s52 offen offset:672 sc1
    s_waitcnt vmcnt(0)
    v_mfma_f32_32x32x4_2b_bf16 v[30:61], v[196:197], v[166:167], 0 cbsz:1 abid:0
    s_nop 15
    s_nop 1
    v_mfma_f32_32x32x16_bf16 v[30:45], v[184:187], v[158:161], v[30:45]
    v_mfma_f32_32x32x16_bf16 v[46:61], v[184:187], v[162:165], v[46:61]
    s_nop 10
    v_sub_f32 v30, v30, v22
    v_sub_f32 v31, v31, v22
    v_sub_f32 v32, v32, v22
    v_sub_f32 v33, v33, v22
    v_sub_f32 v34, v34, v22
    v_sub_f32 v35, v35, v22
    v_sub_f32 v36, v36, v22
    v_sub_f32 v37, v37, v22
    v_sub_f32 v38, v38, v22
    v_sub_f32 v39, v39, v22
    v_sub_f32 v40, v40, v22
    v_sub_f32 v41, v41, v22
    v_sub_f32 v42, v42, v22
    v_sub_f32 v43, v43, v22
    v_sub_f32 v44, v44, v22
    v_sub_f32 v45, v45, v22
    v_sub_f32 v46, v46, v23
    v_sub_f32 v47, v47, v23
    v_sub_f32 v48, v48, v23
    v_sub_f32 v49, v49, v23
    v_sub_f32 v50, v50, v23
    v_sub_f32 v51, v51, v23
    v_sub_f32 v52, v52, v23
    v_sub_f32 v53, v53, v23
    v_sub_f32 v54, v54, v23
    v_sub_f32 v55, v55, v23
    v_sub_f32 v56, v56, v23
    v_sub_f32 v57, v57, v23
    v_sub_f32 v58, v58, v23
    v_sub_f32 v59, v59, v23
    v_sub_f32 v60, v60, v23
    v_sub_f32 v61, v61, v23
    v_exp_f32 v30, v30
    v_exp_f32 v31, v31
    v_exp_f32 v32, v32
    v_exp_f32 v33, v33
    v_cvt_pk_bf16_f32 v168, v30, v31
    v_cvt_pk_bf16_f32 v169, v32, v33
    v_exp_f32 v34, v34
    v_exp_f32 v35, v35
    v_exp_f32 v36, v36
    v_exp_f32 v37, v37
    v_cvt_pk_bf16_f32 v170, v34, v35
    v_cvt_pk_bf16_f32 v171, v36, v37
    v_exp_f32 v38, v38
    v_exp_f32 v39, v39
    v_exp_f32 v40, v40
    v_exp_f32 v41, v41
    v_cvt_pk_bf16_f32 v172, v38, v39
    v_cvt_pk_bf16_f32 v173, v40, v41
    v_exp_f32 v42, v42
    v_exp_f32 v43, v43
    v_exp_f32 v44, v44
    v_exp_f32 v45, v45
    v_cvt_pk_bf16_f32 v174, v42, v43
    v_cvt_pk_bf16_f32 v175, v44, v45
    v_exp_f32 v46, v46
    v_exp_f32 v47, v47
    v_exp_f32 v48, v48
    v_exp_f32 v49, v49
    v_cvt_pk_bf16_f32 v176, v46, v47
    v_cvt_pk_bf16_f32 v177, v48, v49
    v_exp_f32 v50, v50
    v_exp_f32 v51, v51
    v_exp_f32 v52, v52
    v_exp_f32 v53, v53
    v_cvt_pk_bf16_f32 v178, v50, v51
    v_cvt_pk_bf16_f32 v179, v52, v53
    v_exp_f32 v54, v54
    v_exp_f32 v55, v55
    v_exp_f32 v56, v56
    v_exp_f32 v57, v57
    v_cvt_pk_bf16_f32 v180, v54, v55
    v_cvt_pk_bf16_f32 v181, v56, v57
    v_exp_f32 v58, v58
    v_exp_f32 v59, v59
    v_exp_f32 v60, v60
    v_exp_f32 v61, v61
    v_cvt_pk_bf16_f32 v182, v58, v59
    v_cvt_pk_bf16_f32 v183, v60, v61
    v_mfma_f32_32x32x16_bf16 v[126:141], v[188:191], v[168:171], v[126:141]
    v_mfma_f32_32x32x16_bf16 v[126:141], v[192:195], v[172:175], v[126:141]
    v_mfma_f32_32x32x16_bf16 v[142:157], v[188:191], v[176:179], v[142:157]
    v_mfma_f32_32x32x16_bf16 v[142:157], v[192:195], v[180:183], v[142:157]
    s_nop 15
    s_nop 3
    s_add_u32 s50, s50, 1
    s_cmp_lt_u32 s50, 32
    s_cbranch_scc1 L_mega_slow2
    ds_read_b128 v[196:199], v20 offset:0
    ds_read_b128 v[200:203], v20 offset:1024
    ds_read_b128 v[204:207], v20 offset:2048
    ds_read_b128 v[208:211], v20 offset:3072
    ds_read_b128 v[212:215], v20 offset:4096
    ds_read_b128 v[216:219], v20 offset:5120
    ds_read_b128 v[220:223], v20 offset:6144
    ds_read_b128 v[228:231], v20 offset:7168
    ds_read_b128 v[232:235], v20 offset:8192
    ds_read_b128 v[248:251], v20 offset:9216
    ds_read_b128 v[252:255], v20 offset:10240
    ds_read_b128 v[96:99], v20 offset:11264
    ds_read_b128 v[100:103], v20 offset:12288
    ds_read_b128 v[104:107], v20 offset:13312
    ds_read_b128 v[108:111], v20 offset:14336
    ds_read_b128 v[112:115], v20 offset:15360
    ds_read_b128 v[116:119], v20 offset:16384
    ds_read_b128 v[120:123], v20 offset:17408
    ds_read_b128 v[224:227], v20 offset:18432
    ds_read_b128 v[236:239], v20 offset:19456
    ds_read_b128 v[240:243], v26 offset:0
    ds_read_b128 v[244:247], v26 offset:1024
    ds_read_b128 v[48:51], v26 offset:2048
    ds_read_b128 v[52:55], v26 offset:3072
    ds_read_b128 v[56:59], v26 offset:4096
    ds_read_b128 v[60:63], v26 offset:5120
    ds_read_b128 v[64:67], v26 offset:6144
    ds_read_b128 v[68:71], v26 offset:7168
    ds_read_b128 v[72:75], v26 offset:8192
    ds_read_b128 v[76:79], v26 offset:9216
    ds_read_b128 v[80:83], v26 offset:10240
    ds_read_b128 v[84:87], v26 offset:11264
    ds_read_b128 v[88:91], v26 offset:12288
    ds_read_b128 v[92:95], v26 offset:13312
    ds_read_b128 v[168:171], v26 offset:14336
    ds_read_b128 v[172:175], v26 offset:15360
    ds_read_b128 v[176:179], v26 offset:16384
    ds_read_b128 v[180:183], v26 offset:17408
    ds_read_b128 v[184:187], v26 offset:18432
    ds_read_b128 v[188:191], v26 offset:19456
    ds_read_b128 v[192:195], v26 offset:20480
    s_branch L_mega_ep
.p2align 6
.type L_mega_tab,@object
L_mega_tab:
.long 0, 10240, 5120, 10240, 25600, 10240, 30720, 10240
.long 20480, 25600, 51200, 10240, 56320, 10240, 76800, 10240
.long 81920, 10240, 71680, 25600, 102400, 10240, 107520, 10240
.long 128000, 10240, 133120, 10240, 122880, 25600, 153600, 10240
.long 158720, 10240, 179200, 10240, 184320, 10240, 174080, 25600
.long 204800, 10240, 209920, 10240, 230400, 10240, 235520, 10240
.long 225280, 25600, 256000, 10240, 261120, 10240, 281600, 10240
.long 286720, 10240, 276480, 25600, 307200, 10240, 312320, 10240
.long 332800, 10240, 337920, 10240, 327680, 25600, 358400, 10240
.long 363520, 10240, 384000, 10240, 389120, 10240, 378880, 25600
.long 409600, 10240, 414720, 10240, 435200, 10240, 440320, 10240
.long 430080, 25600, 460800, 10240, 465920, 10240, 486400, 10240
.long 491520, 10240, 481280, 25600, 512000, 10240, 517120, 10240
.long 537600, 10240, 542720, 10240, 532480, 25600, 563200, 10240
.long 568320, 10240, 588800, 10240, 593920, 10240, 583680, 25600
.long 614400, 10240, 619520, 10240, 640000, 10240, 645120, 10240
.long 634880, 25600, 665600, 10240, 670720, 10240, 691200, 10240
.long 696320, 10240, 686080, 25600, 716800, 10240, 721920, 10240
.long 742400, 10240, 747520, 10240, 737280, 25600, 768000, 10240
.long 773120, 10240, 793600, 10240, 798720, 10240, 788480, 25600
.long 0, 55296, 13824, 55296, 27648, 55296, 41472, 55296
.long 110592, 55296, 124416, 55296, 138240, 55296, 152064, 55296
.long 276480, 55296, 290304, 55296, 304128, 55296, 317952, 55296
.long 387072, 55296, 400896, 55296, 414720, 55296, 428544, 55296
.long 552960, 55296, 566784, 55296, 580608, 55296, 594432, 55296
.long 663552, 55296, 677376, 55296, 691200, 55296, 705024, 55296
.long 829440, 55296, 843264, 55296, 857088, 55296, 870912, 55296
.long 940032, 55296, 953856, 55296, 967680, 55296, 981504, 55296
.long 1105920, 55296, 1119744, 55296, 1133568, 55296, 1147392, 55296
.long 1216512, 55296, 1230336, 55296, 1244160, 55296, 1257984, 55296
.long 1382400, 55296, 1396224, 55296, 1410048, 55296, 1423872, 55296
.long 1492992, 55296, 1506816, 55296, 1520640, 55296, 1534464, 55296
.long 1658880, 55296, 1672704, 55296, 1686528, 55296, 1700352, 55296
.long 1769472, 55296, 1783296, 55296, 1797120, 55296, 1810944, 55296
.long 1935360, 55296, 1949184, 55296, 1963008, 55296, 1976832, 55296
.long 2045952, 55296, 2059776, 55296, 2073600, 55296, 2087424, 55296
.long 221184, 13824, 248832, 13824, 497664, 13824, 525312, 13824
.long 774144, 13824, 801792, 13824, 1050624, 13824, 1078272, 13824
.long 1327104, 13824, 1354752, 13824, 1603584, 13824, 1631232, 13824
.long 1880064, 13824, 1907712, 13824, 2156544, 13824, 2184192, 13824
.long 0, 20480, 5120, 20480, 10240, 20480, 15360, 20480
.long 40960, 20480, 46080, 20480, 51200, 20480, 56320, 20480
.long 81920, 20480, 87040, 20480, 92160, 20480, 97280, 20480
.long 143360, 20480, 148480, 20480, 153600, 20480, 158720, 20480
.long 184320, 20480, 189440, 20480, 194560, 20480, 199680, 20480
.long 225280, 20480, 230400, 20480, 235520, 20480, 240640, 20480
.long 286720, 20480, 291840, 20480, 296960, 20480, 302080, 20480
.long 327680, 20480, 332800, 20480, 337920, 20480, 343040, 20480
.long 368640, 20480, 373760, 20480, 378880, 20480, 384000, 20480
.long 430080, 20480, 435200, 20480, 440320, 20480, 445440, 20480
.long 471040, 20480, 476160, 20480, 481280, 20480, 486400, 20480
.long 512000, 20480, 517120, 20480, 522240, 20480, 527360, 20480
.long 573440, 20480, 578560, 20480, 583680, 20480, 588800, 20480
.long 614400, 20480, 619520, 20480, 624640, 20480, 629760, 20480
.long 655360, 20480, 660480, 20480, 665600, 20480, 670720, 20480
.long 716800, 20480, 721920, 20480, 727040, 20480, 732160, 20480
.long 757760, 20480, 762880, 20480, 768000, 20480, 773120, 20480
.long 798720, 20480, 803840, 20480, 808960, 20480, 814080, 20480
.long 860160, 20480, 865280, 20480, 870400, 20480, 875520, 20480
.long 901120, 20480, 906240, 20480, 911360, 20480, 916480, 20480
.long 942080, 20480, 947200, 20480, 952320, 20480, 957440, 20480
.long 1003520, 20480, 1008640, 20480, 1013760, 20480, 1018880, 20480
.long 1044480, 20480, 1049600, 20480, 1054720, 20480, 1059840, 20480
.long 1085440, 20480, 1090560, 20480, 1095680, 20480, 1100800, 20480
.long 1146880, 20480, 1152000, 20480, 1157120, 20480, 1162240, 20480
.long 1187840, 20480, 1192960, 20480, 1198080, 20480, 1203200, 20480
.long 1228800, 20480, 1233920, 20480, 1239040, 20480, 1244160, 20480
.long 1290240, 20480, 1295360, 20480, 1300480, 20480, 1305600, 20480
.long 1331200, 20480, 1336320, 20480, 1341440, 20480, 1346560, 20480
.long 1372160, 20480, 1377280, 20480, 1382400, 20480, 1387520, 20480
.long 1433600, 20480, 1438720, 20480, 1443840, 20480, 1448960, 20480
.long 1474560, 20480, 1479680, 20480, 1484800, 20480, 1489920, 20480
.long 1515520, 20480, 1520640, 20480, 1525760, 20480, 1530880, 20480
.long 1576960, 20480, 1582080, 20480, 1587200, 20480, 1592320, 20480
.long 1617920, 20480, 1623040, 20480, 1628160, 20480, 1633280, 20480
.long 1658880, 20480, 1664000, 20480, 1669120, 20480, 1674240, 20480
.long 1720320, 20480, 1725440, 20480, 1730560, 20480, 1735680, 20480
.long 1761280, 20480, 1766400, 20480, 1771520, 20480, 1776640, 20480
.long 1802240, 20480, 1807360, 20480, 1812480, 20480, 1817600, 20480
.long 1863680, 20480, 1868800, 20480, 1873920, 20480, 1879040, 20480
.long 1904640, 20480, 1909760, 20480, 1914880, 20480, 1920000, 20480
.long 1945600, 20480, 1950720, 20480, 1955840, 20480, 1960960, 20480
.long 2007040, 20480, 2012160, 20480, 2017280, 20480, 2022400, 20480
.long 2048000, 20480, 2053120, 20480, 2058240, 20480, 2063360, 20480
.long 2088960, 20480, 2094080, 20480, 2099200, 20480, 2104320, 20480
.long 2150400, 20480, 2155520, 20480, 2160640, 20480, 2165760, 20480
.long 122880, 5120, 133120, 5120, 266240, 5120, 276480, 5120
.long 409600, 5120, 419840, 5120, 552960, 5120, 563200, 5120
.long 696320, 5120, 706560, 5120, 839680, 5120, 849920, 5120
.long 983040, 5120, 993280, 5120, 1126400, 5120, 1136640, 5120
.long 1269760, 5120, 1280000, 5120, 1413120, 5120, 1423360, 5120
.long 1556480, 5120, 1566720, 5120, 1699840, 5120, 1710080, 5120
.long 1843200, 5120, 1853440, 5120, 1986560, 5120, 1996800, 5120
.long 2129920, 5120, 2140160, 5120, 2191360, 5120, 2201600, 5120
L_mega_last:
.size L_mega_tab, .-L_mega_tab
.section .rodata,"a"
.p2align 6
.amdhsa_kernel sequential_preLN__grouped_kv_mqa__mixer_channel_mlp__prompt_kernel
  .amdhsa_next_free_vgpr 256
  .amdhsa_next_free_sgpr 82
  .amdhsa_accum_offset 256
  .amdhsa_group_segment_fixed_size 0
  .amdhsa_kernarg_size 104
  .amdhsa_user_sgpr_count 2
  .amdhsa_user_sgpr_kernarg_segment_ptr 1
  .amdhsa_system_sgpr_workgroup_id_x 1
.end_amdhsa_kernel
```
